```python
import torch

def _softmax(x, axis=-1):
    return torch.softmax(x, dim=axis)
def _gelu(x):
    return torch.nn.functional.gelu(x, approximate="tanh")
def _silu(x):
    return torch.nn.functional.silu(x)
def _sigmoid(x):
    return torch.sigmoid(x)
def _layernorm(x, axis=-1, eps=1e-5):
    m = x.mean(dim=axis, keepdim=True)
    v = x.var(dim=axis, keepdim=True, unbiased=False)
    return (x - m) / torch.sqrt(v + eps)
def _scatter_add(tgt, idx, src, axis=0):
    return tgt.clone().index_add_(axis, idx, src)
def _segment_sum(src, seg, n):
    out = torch.zeros((n,) + src.shape[1:], dtype=src.dtype)
    return out.index_add_(0, seg, src)
def _pad(x, pw):
    flat = tuple(v for pair in reversed(pw) for v in pair)
    return torch.nn.functional.pad(x, flat)

kernel_name = 'sequential_preLN__mha_block_cached__glu_gated_bilinear__decode'

def setup_inputs():

    _w = (lambda a: (lambda t: t.to(torch.bfloat16) if t.is_floating_point() else t)(torch.as_tensor(a)))
    def _A_setup():
        B, Sq, D = 2, 1, 640
        H, Sk, Dh = 32, 4096, 128
        return {
            "x": _w((lambda *s: torch.randn(*s, dtype=torch.bfloat16) * 0.05)(B, Sq, D)),
            "k_cache": _w((lambda *s: torch.randn(*s, dtype=torch.bfloat16) * 1.6)(B, H, Sk, Dh)),
            "v_cache": _w((lambda *s: torch.randn(*s, dtype=torch.bfloat16) * 0.8)(B, H, Sk, Dh)),
            "wq": _w((lambda *s: torch.randn(*s, dtype=torch.bfloat16) * 1.6)(D, H * Dh) * (D ** -0.5)),
            "wo": _w((lambda *s: torch.randn(*s, dtype=torch.bfloat16) * 0.8)(H * Dh, D) * ((H * Dh) ** -0.5)),
        }
    _A_in = _A_setup()

    def _B_setup():
        B, S, D, F = 2, 1, 640, 1728
        return {
            "x": _w((lambda *s: torch.randn(*s, dtype=torch.bfloat16) * 0.05)(B, S, D)),
            "w_gate": _w((lambda *s: torch.randn(*s, dtype=torch.bfloat16) * 0.4)(D, F) * (D ** -0.5)),
            "w_up": _w((lambda *s: torch.randn(*s, dtype=torch.bfloat16) * 0.4)(D, F) * (D ** -0.5)),
            "w_down": _w((lambda *s: torch.randn(*s, dtype=torch.bfloat16) * 0.4)(F, D) * (F ** -0.5)),
        }
    _B_in = _B_setup()

    return {
        "A_x": _A_in["x"],
        "A_k_cache": _A_in["k_cache"],
        "A_v_cache": _A_in["v_cache"],
        "A_wq": _A_in["wq"],
        "A_wo": _A_in["wo"],
        "B_x": _B_in["x"],
        "B_w_gate": _B_in["w_gate"],
        "B_w_up": _B_in["w_up"],
        "B_w_down": _B_in["w_down"],
    }

def reference(A_x, A_k_cache, A_v_cache, A_wq, A_wo, B_x, B_w_gate, B_w_up, B_w_down):
    def _A_ref(x, k_cache, v_cache, wq, wo):
        B, Sq, D = x.shape
        H, Dh = 32, 128
        q = (lambda x, *d: x.permute(*d))((x @ wq).reshape(B, Sq, H, Dh), 0, 2, 1, 3)
        scores = torch.einsum("bhqd,bhkd->bhqk", q, k_cache) * (Dh ** -0.5)
        p = _softmax(scores, axis=-1)
        o = torch.einsum("bhqk,bhkd->bhqd", p, v_cache)
        return (lambda x, *d: x.permute(*d))(o, 0, 2, 1, 3).reshape(B, Sq, H * Dh) @ wo

    def _B_ref(x, w_gate, w_up, w_down):
        g = torch.einsum("bsd,df->bsf", x, w_gate)
        u = torch.einsum("bsd,df->bsf", x, w_up)
        h = g * u
        return torch.einsum("bsf,fd->bsd", h, w_down)

    x = A_x
    h = x + _A_ref(_layernorm(x, axis=-1), A_k_cache, A_v_cache, A_wq, A_wo)
    h2 = h + _B_ref(_layernorm(h, axis=-1), B_w_gate, B_w_up, B_w_down)
    return h2
```

```asm
; @launch grid=(256,1,1) block=(1024,1,1) lds=81920
.amdgcn_target "amdgcn-amd-amdhsa--gfx950"
.text
.globl sequential_preLN__mha_block_cached__glu_gated_bilinear__decode_kernel
.p2align 8
.type sequential_preLN__mha_block_cached__glu_gated_bilinear__decode_kernel,@function
sequential_preLN__mha_block_cached__glu_gated_bilinear__decode_kernel:
  s_cmp_ge_u32 s2, 256
  s_cbranch_scc1 L_end
  s_load_dwordx16 s[16:31], s[0:1], 0
  s_load_dwordx8 s[32:39], s[0:1], 64
  v_lshrrev_b32 v3, 6, v0
  v_and_b32 v0, 63, v0
  v_readfirstlane_b32 s76, v3
  v_lshlrev_b32 v1, 4, v0
  s_lshr_b32 s77, s2, 3
  s_add_u32 s80, s2, s77
  s_and_b32 s80, s80, 7
  s_lshr_b32 s78, s80, 2
  s_and_b32 s79, s80, 3
  s_lshl_b32 s95, s78, 5
  s_add_u32 s95, s95, s77
  s_mul_i32 s6, s79, 12
  s_add_u32 s6, s6, s76
  s_sub_u32 s6, s6, 1
  s_lshl_b32 s6, s6, 14
  s_lshl_b32 s81, s95, 20
  s_add_u32 s81, s81, s6
  s_mov_b32 s89, 0
  s_mul_i32 s6, s2, 52429
  s_lshr_b32 s90, s6, 18
  s_mul_i32 s6, s90, 5
  s_sub_u32 s97, s2, s6
  s_cmp_lt_u32 s2, 135
  s_cselect_b32 s89, 1, 0
  s_cbranch_scc1 L_role1
  s_sub_u32 s90, s2, 135
  s_cmp_lt_u32 s2, 243
  s_cselect_b32 s89, 2, 0
L_role1:
  s_mov_b32 s82, 0
  s_sub_u32 s83, s2, 136
  s_cmp_lt_u32 s2, 136
  s_cbranch_scc1 L_roledone
  s_cmp_lt_u32 s2, 216
  s_cselect_b32 s82, 3, 0
L_roledone:
  s_mov_b32 s86, 0x05040100
  s_mov_b32 s87, 0x07060302
  s_mov_b32 s93, 0x3db504f3
  s_mov_b32 s94, 0x3fb8aa3b
  s_mov_b32 s88, 0
  s_add_u32 s3, s77, s76
  s_lshl_b32 s3, s3, 10
  s_lshl_b32 s96, s95, 7
  s_add_u32 s96, s96, 2621440
  v_and_b32 v19, 15, v0
  v_lshlrev_b32 v19, 5, v19
  v_lshrrev_b32 v20, 4, v0
  v_lshl_add_u32 v20, v20, 3, v19
  s_lshl_b32 s6, s76, 9
  v_add_u32 v21, s6, v20
  s_waitcnt lgkmcnt(0)
  s_mov_b32 s56, s16
  s_mov_b32 s57, s17
  s_mov_b32 s58, 0xa00
  s_mov_b32 s59, 0x20000
  s_mov_b32 s40, s18
  s_mov_b32 s41, s19
  s_mov_b32 s42, 0x4000000
  s_mov_b32 s43, 0x20000
  s_mov_b32 s44, s20
  s_mov_b32 s45, s21
  s_mov_b32 s46, 0x4000000
  s_mov_b32 s47, 0x20000
  s_mov_b32 s48, s22
  s_mov_b32 s49, s23
  s_mov_b32 s50, 0x500000
  s_mov_b32 s51, 0x20000
  s_mov_b32 s52, s38
  s_mov_b32 s53, s39
  s_mov_b32 s54, 0x10000000
  s_mov_b32 s55, 0x20000
  s_mov_b32 s68, s36
  s_mov_b32 s69, s37
  s_mov_b32 s70, 0x100
  s_mov_b32 s71, 0x20000
  s_mov_b32 s72, s34
  s_mov_b32 s73, s35
  s_mov_b32 s74, 0xa00
  s_mov_b32 s75, 0x20000
  s_cmp_eq_u32 s76, 0
  s_cbranch_scc0 L_normb
  s_setprio 3
  v_mov_b32 v9, 0
  ds_write_b32 v9, v9 offset:8576
  s_memrealtime s[8:9]
  v_mul_u32_u24 v3, 20, v0
  buffer_load_dwordx4 v[4:7], v3, s[56:59], 0 offen
  buffer_load_dword v8, v3, s[56:59], 0 offen offset:16
  buffer_load_dwordx4 v[24:27], v3, s[56:59], 0 offen offset:1280
  buffer_load_dword v28, v3, s[56:59], 0 offen offset:1296
  v_lshrrev_b32 v9, 4, v0
  v_and_b32 v10, 15, v0
  s_mov_b32 s6, 163840
  v_mul_lo_u32 v2, v9, s6
  v_lshl_add_u32 v2, v10, 4, v2
  s_mul_i32 s7, s80, 655360
  s_lshl_b32 s6, s77, 8
  s_add_u32 s7, s7, s6
  buffer_load_dwordx4 v[48:51], v2, s[48:51], s7 offen nt
  s_add_u32 s7, s7, 8192
  buffer_load_dwordx4 v[52:55], v2, s[48:51], s7 offen nt
  s_add_u32 s7, s7, 8192
  buffer_load_dwordx4 v[56:59], v2, s[48:51], s7 offen nt
  s_add_u32 s7, s7, 8192
  buffer_load_dwordx4 v[60:63], v2, s[48:51], s7 offen nt
  s_add_u32 s7, s7, 8192
  buffer_load_dwordx4 v[64:67], v2, s[48:51], s7 offen nt
  s_add_u32 s7, s7, 8192
  buffer_load_dwordx4 v[68:71], v2, s[48:51], s7 offen nt
  s_add_u32 s7, s7, 8192
  buffer_load_dwordx4 v[72:75], v2, s[48:51], s7 offen nt
  s_add_u32 s7, s7, 8192
  buffer_load_dwordx4 v[76:79], v2, s[48:51], s7 offen nt
  s_add_u32 s7, s7, 8192
  buffer_load_dwordx4 v[80:83], v2, s[48:51], s7 offen nt
  s_add_u32 s7, s7, 8192
  buffer_load_dwordx4 v[84:87], v2, s[48:51], s7 offen nt
  s_add_u32 s7, s7, 8192
  buffer_load_dwordx4 v[88:91], v2, s[48:51], s7 offen nt
  s_add_u32 s7, s7, 8192
  buffer_load_dwordx4 v[92:95], v2, s[48:51], s7 offen nt
  s_add_u32 s7, s7, 8192
  buffer_load_dwordx4 v[96:99], v2, s[48:51], s7 offen nt
  s_add_u32 s7, s7, 8192
  buffer_load_dwordx4 v[100:103], v2, s[48:51], s7 offen nt
  s_add_u32 s7, s7, 8192
  buffer_load_dwordx4 v[104:107], v2, s[48:51], s7 offen nt
  s_add_u32 s7, s7, 8192
  buffer_load_dwordx4 v[108:111], v2, s[48:51], s7 offen nt
  s_add_u32 s7, s7, 8192
  buffer_load_dwordx4 v[112:115], v2, s[48:51], s7 offen nt
  s_add_u32 s7, s7, 8192
  buffer_load_dwordx4 v[116:119], v2, s[48:51], s7 offen nt
  s_add_u32 s7, s7, 8192
  buffer_load_dwordx4 v[120:123], v2, s[48:51], s7 offen nt
  s_add_u32 s7, s7, 8192
  buffer_load_dwordx4 v[124:127], v2, s[48:51], s7 offen nt
  s_waitcnt lgkmcnt(0)
  s_barrier
  s_lshl_b64 s[8:9], s[8:9], 16
  s_or_b32 s9, s9, 0x80000000
  v_mov_b32 v44, s8
  v_mov_b32 v45, s9
  v_mov_b32 v46, 0
  v_mov_b32 v47, 0
  v_mov_b32 v12, -1
  v_mov_b32 v13, -1
  v_mov_b32 v14, -1
  v_mov_b32 v15, -1
  s_lshl_b32 s12, s77, 3
  s_mov_b64 exec, 1
  buffer_atomic_cmpswap_x2 v[44:47], off, s[68:71], s12 sc0 sc1
  s_lshl_b32 s6, s77, 7
  s_lshl_b32 s7, s80, 3
  s_add_u32 s6, s6, s7
  s_add_u32 s6, s6, 0
  buffer_store_dwordx2 v[12:13], v1, s[52:55], s6 offen sc1
  s_cmp_eq_u32 s79, 0
  s_cbranch_scc0 L_rs2
  v_mov_b32 v9, 0
  buffer_store_dword v9, off, s[52:55], s96 sc1
L_rs2:
  s_lshl_b32 s6, s77, 12
  s_lshl_b32 s7, s80, 9
  s_add_u32 s6, s6, s7
  s_add_u32 s6, s6, 65536
  s_mov_b32 exec_lo, -1
  buffer_store_dwordx4 v[12:15], v1, s[52:55], s6 offen sc1
  s_mov_b64 exec, -1
  s_cmp_lt_u32 s80, 5
  s_cbranch_scc0 L_rs3
  v_lshrrev_b32 v9, 3, v0
  v_lshlrev_b32 v9, 12, v9
  v_and_b32 v10, 7, v0
  v_lshl_add_u32 v9, v10, 4, v9
  s_lshl_b32 s6, s80, 15
  s_lshl_b32 s7, s77, 7
  s_add_u32 s6, s6, s7
  s_add_u32 s6, s6, 262144
  buffer_store_dwordx4 v[12:15], v9, s[52:55], s6 offen sc1
L_rs3:
  s_cmp_eq_u32 s89, 1
  s_cbranch_scc0 L_rs4
  v_lshrrev_b32 v9, 5, v0
  v_mul_u32_u24 v9, 2560, v9
  v_and_b32 v10, 31, v0
  v_lshl_add_u32 v9, v10, 4, v9
  s_mul_i32 s6, s90, 10240
  s_lshl_b32 s7, s97, 9
  s_add_u32 s6, s6, s7
  s_add_u32 s6, s6, 3145728
  s_add_u32 s7, s6, 5120
  buffer_store_dwordx4 v[12:15], v9, s[52:55], s6 offen sc1
  buffer_store_dwordx4 v[12:15], v9, s[52:55], s7 offen sc1
L_rs4:
  s_cmp_eq_u32 s89, 2
  s_cbranch_scc0 L_rsdone
  v_lshrrev_b32 v9, 2, v0
  v_mul_u32_u24 v9, 6912, v9
  v_and_b32 v10, 3, v0
  v_lshl_add_u32 v9, v10, 4, v9
  s_lshl_b32 s6, s90, 6
  s_add_u32 s6, s6, 1048576
  buffer_store_dwordx4 v[12:15], v9, s[52:55], s6 offen sc1
  s_add_u32 s6, s6, 110592
  buffer_store_dwordx4 v[12:15], v9, s[52:55], s6 offen sc1
  s_add_u32 s6, s6, 110592
  buffer_store_dwordx4 v[12:15], v9, s[52:55], s6 offen sc1
  s_add_u32 s6, s6, 110592
  buffer_store_dwordx4 v[12:15], v9, s[52:55], s6 offen sc1
  s_add_u32 s6, s6, 110592
  buffer_store_dwordx4 v[12:15], v9, s[52:55], s6 offen sc1
L_rsdone:
  s_waitcnt vmcnt(23)
  v_lshlrev_b32 v9, 16, v4
  v_and_b32 v10, 0xffff0000, v4
  v_lshlrev_b32 v11, 16, v5
  v_and_b32 v12, 0xffff0000, v5
  v_lshlrev_b32 v13, 16, v6
  v_and_b32 v14, 0xffff0000, v6
  v_lshlrev_b32 v15, 16, v7
  v_and_b32 v16, 0xffff0000, v7
  v_lshlrev_b32 v17, 16, v8
  v_and_b32 v18, 0xffff0000, v8
  v_add_f32 v30, v9, v10
  v_add_f32 v31, v11, v12
  v_add_f32 v30, v30, v13
  v_add_f32 v31, v31, v14
  v_add_f32 v30, v30, v15
  v_add_f32 v31, v31, v16
  v_add_f32 v30, v30, v17
  v_add_f32 v31, v31, v18
  v_add_f32 v30, v30, v31
  s_nop 1
  v_add_f32_dpp v30, v30, v30 quad_perm:[1,0,3,2] row_mask:0xf bank_mask:0xf
  s_nop 1
  v_add_f32_dpp v30, v30, v30 quad_perm:[2,3,0,1] row_mask:0xf bank_mask:0xf
  s_nop 1
  v_add_f32_dpp v30, v30, v30 row_half_mirror row_mask:0xf bank_mask:0xf
  s_nop 1
  v_add_f32_dpp v30, v30, v30 row_mirror row_mask:0xf bank_mask:0xf
  v_mov_b32 v31, v30
  s_nop 1
  v_permlane32_swap_b32 v30, v31
  v_add_f32 v30, v30, v31
  v_mov_b32 v31, v30
  s_nop 1
  v_permlane16_swap_b32 v30, v31
  v_add_f32 v30, v30, v31
  v_mul_f32 v30, 0x3acccccd, v30
  v_sub_f32 v32, v9, v30
  v_mul_f32 v31, v32, v32
  v_sub_f32 v32, v10, v30
  v_fmac_f32 v31, v32, v32
  v_sub_f32 v32, v11, v30
  v_fmac_f32 v31, v32, v32
  v_sub_f32 v32, v12, v30
  v_fmac_f32 v31, v32, v32
  v_sub_f32 v32, v13, v30
  v_fmac_f32 v31, v32, v32
  v_sub_f32 v32, v14, v30
  v_fmac_f32 v31, v32, v32
  v_sub_f32 v32, v15, v30
  v_fmac_f32 v31, v32, v32
  v_sub_f32 v32, v16, v30
  v_fmac_f32 v31, v32, v32
  v_sub_f32 v32, v17, v30
  v_fmac_f32 v31, v32, v32
  v_sub_f32 v32, v18, v30
  v_fmac_f32 v31, v32, v32
  s_nop 1
  v_add_f32_dpp v31, v31, v31 quad_perm:[1,0,3,2] row_mask:0xf bank_mask:0xf
  s_nop 1
  v_add_f32_dpp v31, v31, v31 quad_perm:[2,3,0,1] row_mask:0xf bank_mask:0xf
  s_nop 1
  v_add_f32_dpp v31, v31, v31 row_half_mirror row_mask:0xf bank_mask:0xf
  s_nop 1
  v_add_f32_dpp v31, v31, v31 row_mirror row_mask:0xf bank_mask:0xf
  v_mov_b32 v32, v31
  s_nop 1
  v_permlane32_swap_b32 v31, v32
  v_add_f32 v31, v31, v32
  v_mov_b32 v32, v31
  s_nop 1
  v_permlane16_swap_b32 v31, v32
  v_add_f32 v31, v31, v32
  v_mul_f32 v31, 0x3acccccd, v31
  v_cvt_pk_bf16_f32 v30, v30, v30
  v_and_b32 v30, 0xffff0000, v30
  v_cvt_pk_bf16_f32 v31, v31, v31
  v_and_b32 v31, 0xffff0000, v31
  v_add_f32 v31, 0x3727c5ac, v31
  v_cvt_pk_bf16_f32 v31, v31, v31
  v_and_b32 v31, 0xffff0000, v31
  v_sqrt_f32 v31, v31
  s_nop 0
  v_cvt_pk_bf16_f32 v31, v31, v31
  v_and_b32 v31, 0xffff0000, v31
  v_rcp_f32 v32, v31
  v_sub_f32 v9, v9, v30
  v_sub_f32 v10, v10, v30
  v_cvt_pk_bf16_f32 v4, v9, v10
  v_lshlrev_b32 v9, 16, v4
  v_and_b32 v10, 0xffff0000, v4
  v_mul_f32 v33, v9, v32
  v_fma_f32 v9, -v33, v31, v9
  v_fma_f32 v9, v9, v32, v33
  v_mul_f32 v33, v10, v32
  v_fma_f32 v10, -v33, v31, v10
  v_fma_f32 v10, v10, v32, v33
  v_cvt_pk_bf16_f32 v4, v9, v10
  v_sub_f32 v11, v11, v30
  v_sub_f32 v12, v12, v30
  v_cvt_pk_bf16_f32 v5, v11, v12
  v_lshlrev_b32 v11, 16, v5
  v_and_b32 v12, 0xffff0000, v5
  v_mul_f32 v33, v11, v32
  v_fma_f32 v11, -v33, v31, v11
  v_fma_f32 v11, v11, v32, v33
  v_mul_f32 v33, v12, v32
  v_fma_f32 v12, -v33, v31, v12
  v_fma_f32 v12, v12, v32, v33
  v_cvt_pk_bf16_f32 v5, v11, v12
  v_sub_f32 v13, v13, v30
  v_sub_f32 v14, v14, v30
  v_cvt_pk_bf16_f32 v6, v13, v14
  v_lshlrev_b32 v13, 16, v6
  v_and_b32 v14, 0xffff0000, v6
  v_mul_f32 v33, v13, v32
  v_fma_f32 v13, -v33, v31, v13
  v_fma_f32 v13, v13, v32, v33
  v_mul_f32 v33, v14, v32
  v_fma_f32 v14, -v33, v31, v14
  v_fma_f32 v14, v14, v32, v33
  v_cvt_pk_bf16_f32 v6, v13, v14
  v_sub_f32 v15, v15, v30
  v_sub_f32 v16, v16, v30
  v_cvt_pk_bf16_f32 v7, v15, v16
  v_lshlrev_b32 v15, 16, v7
  v_and_b32 v16, 0xffff0000, v7
  v_mul_f32 v33, v15, v32
  v_fma_f32 v15, -v33, v31, v15
  v_fma_f32 v15, v15, v32, v33
  v_mul_f32 v33, v16, v32
  v_fma_f32 v16, -v33, v31, v16
  v_fma_f32 v16, v16, v32, v33
  v_cvt_pk_bf16_f32 v7, v15, v16
  v_sub_f32 v17, v17, v30
  v_sub_f32 v18, v18, v30
  v_cvt_pk_bf16_f32 v8, v17, v18
  v_lshlrev_b32 v17, 16, v8
  v_and_b32 v18, 0xffff0000, v8
  v_mul_f32 v33, v17, v32
  v_fma_f32 v17, -v33, v31, v17
  v_fma_f32 v17, v17, v32, v33
  v_mul_f32 v33, v18, v32
  v_fma_f32 v18, -v33, v31, v18
  v_fma_f32 v18, v18, v32, v33
  v_cvt_pk_bf16_f32 v8, v17, v18
  v_lshlrev_b32 v9, 16, v24
  v_and_b32 v10, 0xffff0000, v24
  v_lshlrev_b32 v11, 16, v25
  v_and_b32 v12, 0xffff0000, v25
  v_lshlrev_b32 v13, 16, v26
  v_and_b32 v14, 0xffff0000, v26
  v_lshlrev_b32 v15, 16, v27
  v_and_b32 v16, 0xffff0000, v27
  v_lshlrev_b32 v17, 16, v28
  v_and_b32 v18, 0xffff0000, v28
  v_add_f32 v30, v9, v10
  v_add_f32 v31, v11, v12
  v_add_f32 v30, v30, v13
  v_add_f32 v31, v31, v14
  v_add_f32 v30, v30, v15
  v_add_f32 v31, v31, v16
  v_add_f32 v30, v30, v17
  v_add_f32 v31, v31, v18
  v_add_f32 v30, v30, v31
  s_nop 1
  v_add_f32_dpp v30, v30, v30 quad_perm:[1,0,3,2] row_mask:0xf bank_mask:0xf
  s_nop 1
  v_add_f32_dpp v30, v30, v30 quad_perm:[2,3,0,1] row_mask:0xf bank_mask:0xf
  s_nop 1
  v_add_f32_dpp v30, v30, v30 row_half_mirror row_mask:0xf bank_mask:0xf
  s_nop 1
  v_add_f32_dpp v30, v30, v30 row_mirror row_mask:0xf bank_mask:0xf
  v_mov_b32 v31, v30
  s_nop 1
  v_permlane32_swap_b32 v30, v31
  v_add_f32 v30, v30, v31
  v_mov_b32 v31, v30
  s_nop 1
  v_permlane16_swap_b32 v30, v31
  v_add_f32 v30, v30, v31
  v_mul_f32 v30, 0x3acccccd, v30
  v_sub_f32 v32, v9, v30
  v_mul_f32 v31, v32, v32
  v_sub_f32 v32, v10, v30
  v_fmac_f32 v31, v32, v32
  v_sub_f32 v32, v11, v30
  v_fmac_f32 v31, v32, v32
  v_sub_f32 v32, v12, v30
  v_fmac_f32 v31, v32, v32
  v_sub_f32 v32, v13, v30
  v_fmac_f32 v31, v32, v32
  v_sub_f32 v32, v14, v30
  v_fmac_f32 v31, v32, v32
  v_sub_f32 v32, v15, v30
  v_fmac_f32 v31, v32, v32
  v_sub_f32 v32, v16, v30
  v_fmac_f32 v31, v32, v32
  v_sub_f32 v32, v17, v30
  v_fmac_f32 v31, v32, v32
  v_sub_f32 v32, v18, v30
  v_fmac_f32 v31, v32, v32
  s_nop 1
  v_add_f32_dpp v31, v31, v31 quad_perm:[1,0,3,2] row_mask:0xf bank_mask:0xf
  s_nop 1
  v_add_f32_dpp v31, v31, v31 quad_perm:[2,3,0,1] row_mask:0xf bank_mask:0xf
  s_nop 1
  v_add_f32_dpp v31, v31, v31 row_half_mirror row_mask:0xf bank_mask:0xf
  s_nop 1
  v_add_f32_dpp v31, v31, v31 row_mirror row_mask:0xf bank_mask:0xf
  v_mov_b32 v32, v31
  s_nop 1
  v_permlane32_swap_b32 v31, v32
  v_add_f32 v31, v31, v32
  v_mov_b32 v32, v31
  s_nop 1
  v_permlane16_swap_b32 v31, v32
  v_add_f32 v31, v31, v32
  v_mul_f32 v31, 0x3acccccd, v31
  v_cvt_pk_bf16_f32 v30, v30, v30
  v_and_b32 v30, 0xffff0000, v30
  v_cvt_pk_bf16_f32 v31, v31, v31
  v_and_b32 v31, 0xffff0000, v31
  v_add_f32 v31, 0x3727c5ac, v31
  v_cvt_pk_bf16_f32 v31, v31, v31
  v_and_b32 v31, 0xffff0000, v31
  v_sqrt_f32 v31, v31
  s_nop 0
  v_cvt_pk_bf16_f32 v31, v31, v31
  v_and_b32 v31, 0xffff0000, v31
  v_rcp_f32 v32, v31
  v_sub_f32 v9, v9, v30
  v_sub_f32 v10, v10, v30
  v_cvt_pk_bf16_f32 v24, v9, v10
  v_lshlrev_b32 v9, 16, v24
  v_and_b32 v10, 0xffff0000, v24
  v_mul_f32 v33, v9, v32
  v_fma_f32 v9, -v33, v31, v9
  v_fma_f32 v9, v9, v32, v33
  v_mul_f32 v33, v10, v32
  v_fma_f32 v10, -v33, v31, v10
  v_fma_f32 v10, v10, v32, v33
  v_cvt_pk_bf16_f32 v24, v9, v10
  v_sub_f32 v11, v11, v30
  v_sub_f32 v12, v12, v30
  v_cvt_pk_bf16_f32 v25, v11, v12
  v_lshlrev_b32 v11, 16, v25
  v_and_b32 v12, 0xffff0000, v25
  v_mul_f32 v33, v11, v32
  v_fma_f32 v11, -v33, v31, v11
  v_fma_f32 v11, v11, v32, v33
  v_mul_f32 v33, v12, v32
  v_fma_f32 v12, -v33, v31, v12
  v_fma_f32 v12, v12, v32, v33
  v_cvt_pk_bf16_f32 v25, v11, v12
  v_sub_f32 v13, v13, v30
  v_sub_f32 v14, v14, v30
  v_cvt_pk_bf16_f32 v26, v13, v14
  v_lshlrev_b32 v13, 16, v26
  v_and_b32 v14, 0xffff0000, v26
  v_mul_f32 v33, v13, v32
  v_fma_f32 v13, -v33, v31, v13
  v_fma_f32 v13, v13, v32, v33
  v_mul_f32 v33, v14, v32
  v_fma_f32 v14, -v33, v31, v14
  v_fma_f32 v14, v14, v32, v33
  v_cvt_pk_bf16_f32 v26, v13, v14
  v_sub_f32 v15, v15, v30
  v_sub_f32 v16, v16, v30
  v_cvt_pk_bf16_f32 v27, v15, v16
  v_lshlrev_b32 v15, 16, v27
  v_and_b32 v16, 0xffff0000, v27
  v_mul_f32 v33, v15, v32
  v_fma_f32 v15, -v33, v31, v15
  v_fma_f32 v15, v15, v32, v33
  v_mul_f32 v33, v16, v32
  v_fma_f32 v16, -v33, v31, v16
  v_fma_f32 v16, v16, v32, v33
  v_cvt_pk_bf16_f32 v27, v15, v16
  v_sub_f32 v17, v17, v30
  v_sub_f32 v18, v18, v30
  v_cvt_pk_bf16_f32 v28, v17, v18
  v_lshlrev_b32 v17, 16, v28
  v_and_b32 v18, 0xffff0000, v28
  v_mul_f32 v33, v17, v32
  v_fma_f32 v17, -v33, v31, v17
  v_fma_f32 v17, v17, v32, v33
  v_mul_f32 v33, v18, v32
  v_fma_f32 v18, -v33, v31, v18
  v_fma_f32 v18, v18, v32, v33
  v_cvt_pk_bf16_f32 v28, v17, v18
  v_lshrrev_b32 v9, 4, v0
  v_lshlrev_b32 v9, 3, v9
  s_lshl_b32 s6, s80, 5
  v_add_u32 v9, s6, v9
  v_add_u32 v10, 4, v9
  ds_bpermute_b32 v30, v9, v4
  ds_bpermute_b32 v35, v10, v4
  ds_bpermute_b32 v31, v9, v5
  ds_bpermute_b32 v36, v10, v5
  ds_bpermute_b32 v32, v9, v6
  ds_bpermute_b32 v37, v10, v6
  ds_bpermute_b32 v33, v9, v7
  ds_bpermute_b32 v38, v10, v7
  ds_bpermute_b32 v34, v9, v8
  ds_bpermute_b32 v39, v10, v8
  ds_bpermute_b32 v12, v9, v24
  ds_bpermute_b32 v17, v10, v24
  ds_bpermute_b32 v13, v9, v25
  ds_bpermute_b32 v29, v10, v25
  ds_bpermute_b32 v14, v9, v26
  ds_bpermute_b32 v19, v10, v26
  ds_bpermute_b32 v15, v9, v27
  ds_bpermute_b32 v2, v10, v27
  ds_bpermute_b32 v16, v9, v28
  ds_bpermute_b32 v3, v10, v28
  s_waitcnt lgkmcnt(0)
  s_waitcnt vmcnt(3)
  v_perm_b32 v18, v52, v48, s86
  v_perm_b32 v22, v52, v48, s87
  v_dot2_f32_bf16 v4, v18, v30, 0
  v_dot2_f32_bf16 v5, v22, v30, 0
  v_dot2_f32_bf16 v40, v18, v12, 0
  v_dot2_f32_bf16 v41, v22, v12, 0
  v_perm_b32 v23, v53, v49, s86
  v_perm_b32 v28, v53, v49, s87
  v_dot2_f32_bf16 v6, v23, v30, 0
  v_dot2_f32_bf16 v7, v28, v30, 0
  v_dot2_f32_bf16 v42, v23, v12, 0
  v_dot2_f32_bf16 v43, v28, v12, 0
  v_perm_b32 v18, v54, v50, s86
  v_perm_b32 v22, v54, v50, s87
  v_dot2_f32_bf16 v8, v18, v30, 0
  v_dot2_f32_bf16 v9, v22, v30, 0
  v_dot2_f32_bf16 v24, v18, v12, 0
  v_dot2_f32_bf16 v25, v22, v12, 0
  v_perm_b32 v23, v55, v51, s86
  v_perm_b32 v28, v55, v51, s87
  v_dot2_f32_bf16 v10, v23, v30, 0
  v_dot2_f32_bf16 v11, v28, v30, 0
  v_dot2_f32_bf16 v26, v23, v12, 0
  v_dot2_f32_bf16 v27, v28, v12, 0
  v_perm_b32 v18, v60, v56, s86
  v_perm_b32 v22, v60, v56, s87
  v_dot2c_f32_bf16 v4, v18, v31
  v_dot2c_f32_bf16 v5, v22, v31
  v_dot2c_f32_bf16 v40, v18, v13
  v_dot2c_f32_bf16 v41, v22, v13
  v_perm_b32 v23, v61, v57, s86
  v_perm_b32 v28, v61, v57, s87
  v_dot2c_f32_bf16 v6, v23, v31
  v_dot2c_f32_bf16 v7, v28, v31
  v_dot2c_f32_bf16 v42, v23, v13
  v_dot2c_f32_bf16 v43, v28, v13
  v_perm_b32 v18, v62, v58, s86
  v_perm_b32 v22, v62, v58, s87
  v_dot2c_f32_bf16 v8, v18, v31
  v_dot2c_f32_bf16 v9, v22, v31
  v_dot2c_f32_bf16 v24, v18, v13
  v_dot2c_f32_bf16 v25, v22, v13
  v_perm_b32 v23, v63, v59, s86
  v_perm_b32 v28, v63, v59, s87
  v_dot2c_f32_bf16 v10, v23, v31
  v_dot2c_f32_bf16 v11, v28, v31
  v_dot2c_f32_bf16 v26, v23, v13
  v_dot2c_f32_bf16 v27, v28, v13
  v_perm_b32 v18, v68, v64, s86
  v_perm_b32 v22, v68, v64, s87
  v_dot2c_f32_bf16 v4, v18, v32
  v_dot2c_f32_bf16 v5, v22, v32
  v_dot2c_f32_bf16 v40, v18, v14
  v_dot2c_f32_bf16 v41, v22, v14
  v_perm_b32 v23, v69, v65, s86
  v_perm_b32 v28, v69, v65, s87
  v_dot2c_f32_bf16 v6, v23, v32
  v_dot2c_f32_bf16 v7, v28, v32
  v_dot2c_f32_bf16 v42, v23, v14
  v_dot2c_f32_bf16 v43, v28, v14
  v_perm_b32 v18, v70, v66, s86
  v_perm_b32 v22, v70, v66, s87
  v_dot2c_f32_bf16 v8, v18, v32
  v_dot2c_f32_bf16 v9, v22, v32
  v_dot2c_f32_bf16 v24, v18, v14
  v_dot2c_f32_bf16 v25, v22, v14
  v_perm_b32 v23, v71, v67, s86
  v_perm_b32 v28, v71, v67, s87
  v_dot2c_f32_bf16 v10, v23, v32
  v_dot2c_f32_bf16 v11, v28, v32
  v_dot2c_f32_bf16 v26, v23, v14
  v_dot2c_f32_bf16 v27, v28, v14
  v_perm_b32 v18, v76, v72, s86
  v_perm_b32 v22, v76, v72, s87
  v_dot2c_f32_bf16 v4, v18, v33
  v_dot2c_f32_bf16 v5, v22, v33
  v_dot2c_f32_bf16 v40, v18, v15
  v_dot2c_f32_bf16 v41, v22, v15
  v_perm_b32 v23, v77, v73, s86
  v_perm_b32 v28, v77, v73, s87
  v_dot2c_f32_bf16 v6, v23, v33
  v_dot2c_f32_bf16 v7, v28, v33
  v_dot2c_f32_bf16 v42, v23, v15
  v_dot2c_f32_bf16 v43, v28, v15
  v_perm_b32 v18, v78, v74, s86
  v_perm_b32 v22, v78, v74, s87
  v_dot2c_f32_bf16 v8, v18, v33
  v_dot2c_f32_bf16 v9, v22, v33
  v_dot2c_f32_bf16 v24, v18, v15
  v_dot2c_f32_bf16 v25, v22, v15
  v_perm_b32 v23, v79, v75, s86
  v_perm_b32 v28, v79, v75, s87
  v_dot2c_f32_bf16 v10, v23, v33
  v_dot2c_f32_bf16 v11, v28, v33
  v_dot2c_f32_bf16 v26, v23, v15
  v_dot2c_f32_bf16 v27, v28, v15
  v_perm_b32 v18, v84, v80, s86
  v_perm_b32 v22, v84, v80, s87
  v_dot2c_f32_bf16 v4, v18, v34
  v_dot2c_f32_bf16 v5, v22, v34
  v_dot2c_f32_bf16 v40, v18, v16
  v_dot2c_f32_bf16 v41, v22, v16
  v_perm_b32 v23, v85, v81, s86
  v_perm_b32 v28, v85, v81, s87
  v_dot2c_f32_bf16 v6, v23, v34
  v_dot2c_f32_bf16 v7, v28, v34
  v_dot2c_f32_bf16 v42, v23, v16
  v_dot2c_f32_bf16 v43, v28, v16
  v_perm_b32 v18, v86, v82, s86
  v_perm_b32 v22, v86, v82, s87
  v_dot2c_f32_bf16 v8, v18, v34
  v_dot2c_f32_bf16 v9, v22, v34
  v_dot2c_f32_bf16 v24, v18, v16
  v_dot2c_f32_bf16 v25, v22, v16
  v_perm_b32 v23, v87, v83, s86
  v_perm_b32 v28, v87, v83, s87
  v_dot2c_f32_bf16 v10, v23, v34
  v_dot2c_f32_bf16 v11, v28, v34
  v_dot2c_f32_bf16 v26, v23, v16
  v_dot2c_f32_bf16 v27, v28, v16
  v_perm_b32 v18, v92, v88, s86
  v_perm_b32 v22, v92, v88, s87
  v_dot2c_f32_bf16 v4, v18, v35
  v_dot2c_f32_bf16 v5, v22, v35
  v_dot2c_f32_bf16 v40, v18, v17
  v_dot2c_f32_bf16 v41, v22, v17
  v_perm_b32 v23, v93, v89, s86
  v_perm_b32 v28, v93, v89, s87
  v_dot2c_f32_bf16 v6, v23, v35
  v_dot2c_f32_bf16 v7, v28, v35
  v_dot2c_f32_bf16 v42, v23, v17
  v_dot2c_f32_bf16 v43, v28, v17
  v_perm_b32 v18, v94, v90, s86
  v_perm_b32 v22, v94, v90, s87
  v_dot2c_f32_bf16 v8, v18, v35
  v_dot2c_f32_bf16 v9, v22, v35
  v_dot2c_f32_bf16 v24, v18, v17
  v_dot2c_f32_bf16 v25, v22, v17
  v_perm_b32 v23, v95, v91, s86
  v_perm_b32 v28, v95, v91, s87
  v_dot2c_f32_bf16 v10, v23, v35
  v_dot2c_f32_bf16 v11, v28, v35
  v_dot2c_f32_bf16 v26, v23, v17
  v_dot2c_f32_bf16 v27, v28, v17
  v_perm_b32 v18, v100, v96, s86
  v_perm_b32 v22, v100, v96, s87
  v_dot2c_f32_bf16 v4, v18, v36
  v_dot2c_f32_bf16 v5, v22, v36
  v_dot2c_f32_bf16 v40, v18, v29
  v_dot2c_f32_bf16 v41, v22, v29
  v_perm_b32 v23, v101, v97, s86
  v_perm_b32 v28, v101, v97, s87
  v_dot2c_f32_bf16 v6, v23, v36
  v_dot2c_f32_bf16 v7, v28, v36
  v_dot2c_f32_bf16 v42, v23, v29
  v_dot2c_f32_bf16 v43, v28, v29
  v_perm_b32 v18, v102, v98, s86
  v_perm_b32 v22, v102, v98, s87
  v_dot2c_f32_bf16 v8, v18, v36
  v_dot2c_f32_bf16 v9, v22, v36
  v_dot2c_f32_bf16 v24, v18, v29
  v_dot2c_f32_bf16 v25, v22, v29
  v_perm_b32 v23, v103, v99, s86
  v_perm_b32 v28, v103, v99, s87
  v_dot2c_f32_bf16 v10, v23, v36
  v_dot2c_f32_bf16 v11, v28, v36
  v_dot2c_f32_bf16 v26, v23, v29
  v_dot2c_f32_bf16 v27, v28, v29
  v_perm_b32 v18, v108, v104, s86
  v_perm_b32 v22, v108, v104, s87
  v_dot2c_f32_bf16 v4, v18, v37
  v_dot2c_f32_bf16 v5, v22, v37
  v_dot2c_f32_bf16 v40, v18, v19
  v_dot2c_f32_bf16 v41, v22, v19
  v_perm_b32 v23, v109, v105, s86
  v_perm_b32 v28, v109, v105, s87
  v_dot2c_f32_bf16 v6, v23, v37
  v_dot2c_f32_bf16 v7, v28, v37
  v_dot2c_f32_bf16 v42, v23, v19
  v_dot2c_f32_bf16 v43, v28, v19
  v_perm_b32 v18, v110, v106, s86
  v_perm_b32 v22, v110, v106, s87
  v_dot2c_f32_bf16 v8, v18, v37
  v_dot2c_f32_bf16 v9, v22, v37
  v_dot2c_f32_bf16 v24, v18, v19
  v_dot2c_f32_bf16 v25, v22, v19
  v_perm_b32 v23, v111, v107, s86
  v_perm_b32 v28, v111, v107, s87
  v_dot2c_f32_bf16 v10, v23, v37
  v_dot2c_f32_bf16 v11, v28, v37
  v_dot2c_f32_bf16 v26, v23, v19
  v_dot2c_f32_bf16 v27, v28, v19
  v_perm_b32 v18, v116, v112, s86
  v_perm_b32 v22, v116, v112, s87
  v_dot2c_f32_bf16 v4, v18, v38
  v_dot2c_f32_bf16 v5, v22, v38
  v_dot2c_f32_bf16 v40, v18, v2
  v_dot2c_f32_bf16 v41, v22, v2
  v_perm_b32 v23, v117, v113, s86
  v_perm_b32 v28, v117, v113, s87
  v_dot2c_f32_bf16 v6, v23, v38
  v_dot2c_f32_bf16 v7, v28, v38
  v_dot2c_f32_bf16 v42, v23, v2
  v_dot2c_f32_bf16 v43, v28, v2
  v_perm_b32 v18, v118, v114, s86
  v_perm_b32 v22, v118, v114, s87
  v_dot2c_f32_bf16 v8, v18, v38
  v_dot2c_f32_bf16 v9, v22, v38
  v_dot2c_f32_bf16 v24, v18, v2
  v_dot2c_f32_bf16 v25, v22, v2
  v_perm_b32 v23, v119, v115, s86
  v_perm_b32 v28, v119, v115, s87
  v_dot2c_f32_bf16 v10, v23, v38
  v_dot2c_f32_bf16 v11, v28, v38
  v_dot2c_f32_bf16 v26, v23, v2
  v_dot2c_f32_bf16 v27, v28, v2
  v_perm_b32 v18, v124, v120, s86
  v_perm_b32 v22, v124, v120, s87
  v_dot2c_f32_bf16 v4, v18, v39
  v_dot2c_f32_bf16 v5, v22, v39
  v_dot2c_f32_bf16 v40, v18, v3
  v_dot2c_f32_bf16 v41, v22, v3
  v_perm_b32 v23, v125, v121, s86
  v_perm_b32 v28, v125, v121, s87
  v_dot2c_f32_bf16 v6, v23, v39
  v_dot2c_f32_bf16 v7, v28, v39
  v_dot2c_f32_bf16 v42, v23, v3
  v_dot2c_f32_bf16 v43, v28, v3
  v_perm_b32 v18, v126, v122, s86
  v_perm_b32 v22, v126, v122, s87
  v_dot2c_f32_bf16 v8, v18, v39
  v_dot2c_f32_bf16 v9, v22, v39
  v_dot2c_f32_bf16 v24, v18, v3
  v_dot2c_f32_bf16 v25, v22, v3
  v_perm_b32 v23, v127, v123, s86
  v_perm_b32 v28, v127, v123, s87
  v_dot2c_f32_bf16 v10, v23, v39
  v_dot2c_f32_bf16 v11, v28, v39
  v_dot2c_f32_bf16 v26, v23, v3
  v_dot2c_f32_bf16 v27, v28, v3
  s_nop 2
  v_mov_b32 v36, v24
  v_mov_b32 v37, v25
  v_mov_b32 v38, v26
  v_mov_b32 v39, v27
  v_mov_b32 v32, v40
  v_mov_b32 v33, v41
  v_mov_b32 v34, v42
  v_mov_b32 v35, v43
  s_nop 2
  v_permlane32_swap_b32 v4, v8
  v_permlane32_swap_b32 v5, v9
  v_permlane32_swap_b32 v6, v10
  v_permlane32_swap_b32 v7, v11
  v_add_f32 v4, v4, v8
  v_add_f32 v5, v5, v9
  v_add_f32 v6, v6, v10
  v_add_f32 v7, v7, v11
  s_nop 0
  v_permlane16_swap_b32 v4, v6
  v_permlane16_swap_b32 v5, v7
  v_add_f32 v4, v4, v6
  v_add_f32 v5, v5, v7
  s_nop 2
  v_permlane32_swap_b32 v32, v36
  v_permlane32_swap_b32 v33, v37
  v_permlane32_swap_b32 v34, v38
  v_permlane32_swap_b32 v35, v39
  v_add_f32 v32, v32, v36
  v_add_f32 v33, v33, v37
  v_add_f32 v34, v34, v38
  v_add_f32 v35, v35, v39
  s_nop 0
  v_permlane16_swap_b32 v32, v34
  v_permlane16_swap_b32 v33, v35
  v_add_f32 v32, v32, v34
  v_add_f32 v33, v33, v35
  s_waitcnt vmcnt(0)
  v_readfirstlane_b32 s10, v44
  v_readfirstlane_b32 s11, v45
  s_nop 3
  s_cmp_eq_u64 s[10:11], 0
  s_cselect_b32 s10, s8, s10
  s_cselect_b32 s11, s9, s11
  s_and_b32 s10, s10, 0xffff0000
  v_mov_b32 v6, s10
  v_mov_b32 v7, s11
  v_mov_b32 v34, s10
  v_mov_b32 v35, s11
  v_lshlrev_b32 v2, 1, v20
  s_lshl_b32 s9, s77, 14
  s_lshl_b32 s8, s80, 11
  s_add_u32 s8, s9, s8
  s_add_u32 s8, s8, 2097152
  buffer_store_dwordx4 v[4:7], v2, s[52:55], s8 offen sc1
  buffer_store_dwordx4 v[32:35], v2, s[52:55], s8 offen offset:1024 sc1
  v_mov_b32 v3, 1
  s_mov_b64 exec, 1
  buffer_atomic_add v3, off, s[68:71], s12 sc1
  s_mov_b64 exec, -1
  s_lshl_b32 s7, s78, 10
  s_add_u32 s9, s9, s7
  s_add_u32 s9, s9, 2097152
L_qpoll:
  s_mov_b32 s7, s9
  buffer_load_dwordx4 v[24:27], v1, s[52:55], s7 offen offset:0 sc1
  buffer_load_dwordx4 v[28:31], v1, s[52:55], s7 offen offset:2048 sc1
  s_add_u32 s7, s7, 4096
  buffer_load_dwordx4 v[32:35], v1, s[52:55], s7 offen offset:0 sc1
  buffer_load_dwordx4 v[36:39], v1, s[52:55], s7 offen offset:2048 sc1
  s_add_u32 s7, s7, 4096
  buffer_load_dwordx4 v[40:43], v1, s[52:55], s7 offen offset:0 sc1
  buffer_load_dwordx4 v[44:47], v1, s[52:55], s7 offen offset:2048 sc1
  s_add_u32 s7, s7, 4096
  buffer_load_dwordx4 v[48:51], v1, s[52:55], s7 offen offset:0 sc1
  buffer_load_dwordx4 v[52:55], v1, s[52:55], s7 offen offset:2048 sc1
  s_add_u32 s7, s7, 4096
  s_waitcnt vmcnt(0)
  v_xor_b32 v2, s10, v26
  v_xor_b32 v3, s11, v27
  v_xor_b32 v4, s10, v30
  v_xor_b32 v5, s11, v31
  v_or3_b32 v2, v2, v4, v5
  v_xor_b32 v4, s10, v34
  v_xor_b32 v5, s11, v35
  v_or3_b32 v2, v2, v4, v5
  v_xor_b32 v4, s10, v38
  v_xor_b32 v5, s11, v39
  v_or3_b32 v2, v2, v4, v5
  v_xor_b32 v4, s10, v42
  v_xor_b32 v5, s11, v43
  v_or3_b32 v2, v2, v4, v5
  v_xor_b32 v4, s10, v46
  v_xor_b32 v5, s11, v47
  v_or3_b32 v2, v2, v4, v5
  v_xor_b32 v4, s10, v50
  v_xor_b32 v5, s11, v51
  v_or3_b32 v2, v2, v4, v5
  v_xor_b32 v4, s10, v54
  v_xor_b32 v5, s11, v55
  v_or3_b32 v2, v2, v4, v5
  v_or_b32 v2, v2, v3
  v_cmp_ne_u32 vcc, 0, v2
  s_cbranch_vccz L_qgo
  s_add_u32 s88, s88, 1
  s_cmp_gt_u32 s88, 0x40000
  s_cbranch_scc1 L_qgo
  s_branch L_qpoll
L_qgo:
  v_add_f32 v24, v24, v28
  v_add_f32 v25, v25, v29
  v_add_f32 v32, v32, v36
  v_add_f32 v33, v33, v37
  v_add_f32 v40, v40, v44
  v_add_f32 v41, v41, v45
  v_add_f32 v48, v48, v52
  v_add_f32 v49, v49, v53
  v_add_f32 v24, v24, v32
  v_add_f32 v25, v25, v33
  v_add_f32 v40, v40, v48
  v_add_f32 v41, v41, v49
  v_add_f32 v24, v24, v40
  v_add_f32 v25, v25, v41
  v_cvt_pk_bf16_f32 v24, v24, v25
  v_lshlrev_b32 v2, 2, v0
  ds_write_b32 v2, v24 offset:8192
  v_mov_b32 v2, 0
  v_mov_b32 v3, 1
  s_waitcnt lgkmcnt(0)
  ds_write_b32 v2, v3 offset:8576
  s_setprio 1
  s_branch L_norm0
L_normb:
  s_setprio 1
  s_mov_b32 s15, s76
L_dma0:
  s_mov_b32 s60, s24
  s_mov_b32 s61, s25
  s_cmp_lt_u32 s80, 5
  s_cselect_b32 s62, 5242880, 0
  s_mov_b32 s63, 0x20000
  s_lshl_b32 s12, s77, 7
  s_lshl_b32 s6, s15, 2
  s_add_u32 s12, s12, s6
  s_mul_i32 s12, s12, 1280
  s_lshl_b32 s7, s80, 8
  s_add_u32 s12, s12, s7
  s_add_u32 s13, s12, 81920
  v_lshrrev_b32 v14, 4, v0
  v_mul_u32_u24 v14, 1280, v14
  v_and_b32 v15, 15, v0
  v_lshl_add_u32 v14, v15, 4, v14
  s_lshl_b32 s8, s15, 10
  s_mov_b32 s64, s28
  s_mov_b32 s65, s29
  s_mov_b32 s66, 0x0
  s_mov_b32 s67, 0x20000
  s_mov_b32 s48, s30
  s_mov_b32 s49, s31
  s_mov_b32 s50, 0x0
  s_mov_b32 s51, 0x20000
  s_mov_b32 s10, 0
  s_mov_b32 s11, 0
  v_mov_b32 v16, v1
  s_cmp_eq_u32 s89, 1
  s_cbranch_scc0 L_dma2
  s_mov_b32 s66, 2211840
  s_mov_b32 s50, 2211840
  v_lshrrev_b32 v16, 3, v0
  v_mul_u32_u24 v16, 3456, v16
  v_and_b32 v17, 7, v0
  v_lshl_add_u32 v16, v17, 4, v16
  s_lshl_b32 s6, s97, 7
  s_lshl_b32 s7, s15, 3
  s_add_u32 s6, s6, s7
  s_mul_i32 s10, s6, 3456
  s_lshl_b32 s7, s90, 7
  s_add_u32 s10, s10, s7
  s_mov_b32 s11, s10
  s_branch L_dma3
L_dma2:
  s_cmp_eq_u32 s89, 2
  s_cbranch_scc0 L_dma3
  s_mov_b32 s64, s32
  s_mov_b32 s65, s33
  s_mov_b32 s48, s32
  s_mov_b32 s49, s33
  s_mul_i32 s10, s90, 20480
  s_add_u32 s66, s10, 20480
  s_add_u32 s50, s10, 20480
  s_add_u32 s10, s10, s8
  s_add_u32 s11, s10, 16384
L_dma3:
  s_add_u32 s9, s8, 16384
  s_mov_b32 m0, s9
  s_cmp_eq_u32 s15, 0
  s_cbranch_scc1 L_dma4
  s_barrier
L_dma4:
  s_cmp_lt_u32 s80, 5
  s_cbranch_scc0 L_dma5
  s_add_u32 s9, s9, 16384
  buffer_load_dwordx4 v14, s[60:63], s12 offen nt lds
  s_mov_b32 m0, s9
  s_nop 0
  buffer_load_dwordx4 v14, s[60:63], s13 offen nt lds
L_dma5:
  s_cmp_eq_u32 s89, 0
  s_cbranch_scc1 L_dma6
  s_add_u32 s9, s8, 49152
  s_mov_b32 m0, s9
  s_add_u32 s9, s9, 16384
  buffer_load_dwordx4 v16, s[64:67], s10 offen nt lds
  s_mov_b32 m0, s9
  s_cmp_lt_u32 s11, s50
  s_cbranch_scc0 L_dma6
  buffer_load_dwordx4 v16, s[48:51], s11 offen nt lds
L_dma6:
  s_cmp_eq_u32 s15, 15
  s_mov_b32 s15, 0
  s_cbranch_scc1 L_dma0
L_norm0:
  v_mov_b32 v10, 0
  v_mov_b32 v11, 0
  v_mov_b32 v12, 0
  v_mov_b32 v13, 0
  v_mov_b32 v14, 0
  v_mov_b32 v15, 0
  v_mov_b32 v16, 0
  v_mov_b32 v17, 0
  v_mov_b32 v19, 0xff61b1e6
  v_mov_b32 v20, 0
  s_cmp_eq_u32 s76, 0
  s_cbranch_scc1 L_claim0
  s_cmp_gt_u32 s76, 12
  s_cbranch_scc1 L_claim0
  s_cmp_gt_u32 s76, 12
  s_cbranch_scc1 L_idle
L_chunk:
  s_add_u32 s6, s3, 0
  s_and_b32 s6, s6, 0x3fff
  s_add_u32 s6, s6, s81
  buffer_load_dwordx4 v[64:67], v1, s[40:43], s6 offen nt
  s_add_u32 s6, s3, 1024
  s_and_b32 s6, s6, 0x3fff
  s_add_u32 s6, s6, s81
  buffer_load_dwordx4 v[68:71], v1, s[40:43], s6 offen nt
  s_add_u32 s6, s3, 2048
  s_and_b32 s6, s6, 0x3fff
  s_add_u32 s6, s6, s81
  buffer_load_dwordx4 v[72:75], v1, s[40:43], s6 offen nt
  s_add_u32 s6, s3, 3072
  s_and_b32 s6, s6, 0x3fff
  s_add_u32 s6, s6, s81
  buffer_load_dwordx4 v[76:79], v1, s[40:43], s6 offen nt
  s_add_u32 s6, s3, 4096
  s_and_b32 s6, s6, 0x3fff
  s_add_u32 s6, s6, s81
  buffer_load_dwordx4 v[80:83], v1, s[40:43], s6 offen nt
  s_add_u32 s6, s3, 5120
  s_and_b32 s6, s6, 0x3fff
  s_add_u32 s6, s6, s81
  buffer_load_dwordx4 v[84:87], v1, s[40:43], s6 offen nt
  s_add_u32 s6, s3, 6144
  s_and_b32 s6, s6, 0x3fff
  s_add_u32 s6, s6, s81
  buffer_load_dwordx4 v[88:91], v1, s[40:43], s6 offen nt
  s_add_u32 s6, s3, 7168
  s_and_b32 s6, s6, 0x3fff
  s_add_u32 s6, s6, s81
  buffer_load_dwordx4 v[92:95], v1, s[40:43], s6 offen nt
  s_add_u32 s6, s3, 8192
  s_and_b32 s6, s6, 0x3fff
  s_add_u32 s6, s6, s81
  buffer_load_dwordx4 v[96:99], v1, s[40:43], s6 offen nt
  s_add_u32 s6, s3, 9216
  s_and_b32 s6, s6, 0x3fff
  s_add_u32 s6, s6, s81
  buffer_load_dwordx4 v[100:103], v1, s[40:43], s6 offen nt
  s_add_u32 s6, s3, 10240
  s_and_b32 s6, s6, 0x3fff
  s_add_u32 s6, s6, s81
  buffer_load_dwordx4 v[104:107], v1, s[40:43], s6 offen nt
  s_add_u32 s6, s3, 11264
  s_and_b32 s6, s6, 0x3fff
  s_add_u32 s6, s6, s81
  buffer_load_dwordx4 v[108:111], v1, s[40:43], s6 offen nt
  s_add_u32 s6, s3, 12288
  s_and_b32 s6, s6, 0x3fff
  s_add_u32 s6, s6, s81
  buffer_load_dwordx4 v[112:115], v1, s[40:43], s6 offen nt
  s_add_u32 s6, s3, 13312
  s_and_b32 s6, s6, 0x3fff
  s_add_u32 s6, s6, s81
  buffer_load_dwordx4 v[116:119], v1, s[40:43], s6 offen nt
  s_add_u32 s6, s3, 14336
  s_and_b32 s6, s6, 0x3fff
  s_add_u32 s6, s6, s81
  buffer_load_dwordx4 v[120:123], v1, s[40:43], s6 offen nt
  s_add_u32 s6, s3, 15360
  s_and_b32 s6, s6, 0x3fff
  s_add_u32 s6, s6, s81
  buffer_load_dwordx4 v[124:127], v1, s[40:43], s6 offen nt
  s_add_u32 s6, s3, 0
  s_and_b32 s6, s6, 0x3fff
  s_add_u32 s6, s6, s81
  buffer_load_dwordx4 v[24:27], v1, s[44:47], s6 offen nt
  s_add_u32 s6, s3, 1024
  s_and_b32 s6, s6, 0x3fff
  s_add_u32 s6, s6, s81
  buffer_load_dwordx4 v[28:31], v1, s[44:47], s6 offen nt
  s_add_u32 s6, s3, 2048
  s_and_b32 s6, s6, 0x3fff
  s_add_u32 s6, s6, s81
  buffer_load_dwordx4 v[32:35], v1, s[44:47], s6 offen nt
  s_add_u32 s6, s3, 3072
  s_and_b32 s6, s6, 0x3fff
  s_add_u32 s6, s6, s81
  buffer_load_dwordx4 v[36:39], v1, s[44:47], s6 offen nt
  s_add_u32 s6, s3, 4096
  s_and_b32 s6, s6, 0x3fff
  s_add_u32 s6, s6, s81
  buffer_load_dwordx4 v[40:43], v1, s[44:47], s6 offen nt
  s_add_u32 s6, s3, 5120
  s_and_b32 s6, s6, 0x3fff
  s_add_u32 s6, s6, s81
  buffer_load_dwordx4 v[44:47], v1, s[44:47], s6 offen nt
  s_add_u32 s6, s3, 6144
  s_and_b32 s6, s6, 0x3fff
  s_add_u32 s6, s6, s81
  buffer_load_dwordx4 v[48:51], v1, s[44:47], s6 offen nt
  s_add_u32 s6, s3, 7168
  s_and_b32 s6, s6, 0x3fff
  s_add_u32 s6, s6, s81
  buffer_load_dwordx4 v[52:55], v1, s[44:47], s6 offen nt
  s_add_u32 s6, s3, 8192
  s_and_b32 s6, s6, 0x3fff
  s_add_u32 s6, s6, s81
  buffer_load_dwordx4 v[56:59], v1, s[44:47], s6 offen nt
  s_add_u32 s6, s3, 9216
  s_and_b32 s6, s6, 0x3fff
  s_add_u32 s6, s6, s81
  buffer_load_dwordx4 v[60:63], v1, s[44:47], s6 offen nt
  v_mov_b32 v6, 0
L_qwaita:
  ds_read_b32 v2, v6 offset:8576
  s_waitcnt lgkmcnt(0)
  v_readfirstlane_b32 s6, v2
  s_cmp_eq_u32 s6, 1
  s_cbranch_scc1 L_qoka
  s_add_u32 s88, s88, 1
  s_cmp_gt_u32 s88, 0x40000
  s_cbranch_scc1 L_qoka
  s_sleep 2
  s_branch L_qwaita
L_qoka:
  v_and_b32 v6, 15, v0
  v_lshlrev_b32 v6, 4, v6
  ds_read_b128 v[2:5], v6 offset:8192
  s_waitcnt lgkmcnt(0)
  s_waitcnt vmcnt(22)
  v_dot2_f32_bf16 v64, v64, v2, 0
  v_dot2_f32_bf16 v68, v68, v2, 0
  v_dot2_f32_bf16 v72, v72, v2, 0
  v_dot2_f32_bf16 v76, v76, v2, 0
  v_dot2c_f32_bf16 v64, v65, v3
  v_dot2c_f32_bf16 v68, v69, v3
  v_dot2c_f32_bf16 v72, v73, v3
  v_dot2c_f32_bf16 v76, v77, v3
  v_dot2c_f32_bf16 v64, v66, v4
  v_dot2c_f32_bf16 v68, v70, v4
  v_dot2c_f32_bf16 v72, v74, v4
  v_dot2c_f32_bf16 v76, v78, v4
  v_dot2c_f32_bf16 v64, v67, v5
  v_dot2c_f32_bf16 v68, v71, v5
  v_dot2c_f32_bf16 v72, v75, v5
  v_dot2c_f32_bf16 v76, v79, v5
  v_add_f32_dpp v64, v64, v64 quad_perm:[1,0,3,2] row_mask:0xf bank_mask:0xf
  v_add_f32_dpp v68, v68, v68 quad_perm:[1,0,3,2] row_mask:0xf bank_mask:0xf
  v_add_f32_dpp v72, v72, v72 quad_perm:[1,0,3,2] row_mask:0xf bank_mask:0xf
  v_add_f32_dpp v76, v76, v76 quad_perm:[1,0,3,2] row_mask:0xf bank_mask:0xf
  v_add_f32_dpp v64, v64, v64 quad_perm:[2,3,0,1] row_mask:0xf bank_mask:0xf
  v_add_f32_dpp v68, v68, v68 quad_perm:[2,3,0,1] row_mask:0xf bank_mask:0xf
  v_add_f32_dpp v72, v72, v72 quad_perm:[2,3,0,1] row_mask:0xf bank_mask:0xf
  v_add_f32_dpp v76, v76, v76 quad_perm:[2,3,0,1] row_mask:0xf bank_mask:0xf
  v_add_f32_dpp v64, v64, v64 row_half_mirror row_mask:0xf bank_mask:0xf
  v_add_f32_dpp v68, v68, v68 row_half_mirror row_mask:0xf bank_mask:0xf
  v_add_f32_dpp v72, v72, v72 row_half_mirror row_mask:0xf bank_mask:0xf
  v_add_f32_dpp v76, v76, v76 row_half_mirror row_mask:0xf bank_mask:0xf
  v_add_f32_dpp v64, v64, v64 row_mirror row_mask:0xf bank_mask:0xf
  v_add_f32_dpp v68, v68, v68 row_mirror row_mask:0xf bank_mask:0xf
  v_add_f32_dpp v72, v72, v72 row_mirror row_mask:0xf bank_mask:0xf
  v_add_f32_dpp v76, v76, v76 row_mirror row_mask:0xf bank_mask:0xf
  v_cvt_pk_bf16_f32 v6, v64, v68
  v_lshlrev_b32 v64, 16, v6
  v_and_b32 v68, 0xffff0000, v6
  v_mul_f32 v64, s93, v64
  v_mul_f32 v68, s93, v68
  v_cvt_pk_bf16_f32 v6, v64, v68
  v_lshlrev_b32 v64, 16, v6
  v_and_b32 v68, 0xffff0000, v6
  v_cvt_pk_bf16_f32 v6, v72, v76
  v_lshlrev_b32 v72, 16, v6
  v_and_b32 v76, 0xffff0000, v6
  v_mul_f32 v72, s93, v72
  v_mul_f32 v76, s93, v76
  v_cvt_pk_bf16_f32 v6, v72, v76
  v_lshlrev_b32 v72, 16, v6
  v_and_b32 v76, 0xffff0000, v6
  s_waitcnt vmcnt(18)
  v_dot2_f32_bf16 v80, v80, v2, 0
  v_dot2_f32_bf16 v84, v84, v2, 0
  v_dot2_f32_bf16 v88, v88, v2, 0
  v_dot2_f32_bf16 v92, v92, v2, 0
  v_dot2c_f32_bf16 v80, v81, v3
  v_dot2c_f32_bf16 v84, v85, v3
  v_dot2c_f32_bf16 v88, v89, v3
  v_dot2c_f32_bf16 v92, v93, v3
  v_dot2c_f32_bf16 v80, v82, v4
  v_dot2c_f32_bf16 v84, v86, v4
  v_dot2c_f32_bf16 v88, v90, v4
  v_dot2c_f32_bf16 v92, v94, v4
  v_dot2c_f32_bf16 v80, v83, v5
  v_dot2c_f32_bf16 v84, v87, v5
  v_dot2c_f32_bf16 v88, v91, v5
  v_dot2c_f32_bf16 v92, v95, v5
  v_add_f32_dpp v80, v80, v80 quad_perm:[1,0,3,2] row_mask:0xf bank_mask:0xf
  v_add_f32_dpp v84, v84, v84 quad_perm:[1,0,3,2] row_mask:0xf bank_mask:0xf
  v_add_f32_dpp v88, v88, v88 quad_perm:[1,0,3,2] row_mask:0xf bank_mask:0xf
  v_add_f32_dpp v92, v92, v92 quad_perm:[1,0,3,2] row_mask:0xf bank_mask:0xf
  v_add_f32_dpp v80, v80, v80 quad_perm:[2,3,0,1] row_mask:0xf bank_mask:0xf
  v_add_f32_dpp v84, v84, v84 quad_perm:[2,3,0,1] row_mask:0xf bank_mask:0xf
  v_add_f32_dpp v88, v88, v88 quad_perm:[2,3,0,1] row_mask:0xf bank_mask:0xf
  v_add_f32_dpp v92, v92, v92 quad_perm:[2,3,0,1] row_mask:0xf bank_mask:0xf
  v_add_f32_dpp v80, v80, v80 row_half_mirror row_mask:0xf bank_mask:0xf
  v_add_f32_dpp v84, v84, v84 row_half_mirror row_mask:0xf bank_mask:0xf
  v_add_f32_dpp v88, v88, v88 row_half_mirror row_mask:0xf bank_mask:0xf
  v_add_f32_dpp v92, v92, v92 row_half_mirror row_mask:0xf bank_mask:0xf
  v_add_f32_dpp v80, v80, v80 row_mirror row_mask:0xf bank_mask:0xf
  v_add_f32_dpp v84, v84, v84 row_mirror row_mask:0xf bank_mask:0xf
  v_add_f32_dpp v88, v88, v88 row_mirror row_mask:0xf bank_mask:0xf
  v_add_f32_dpp v92, v92, v92 row_mirror row_mask:0xf bank_mask:0xf
  v_cvt_pk_bf16_f32 v6, v80, v84
  v_lshlrev_b32 v80, 16, v6
  v_and_b32 v84, 0xffff0000, v6
  v_mul_f32 v80, s93, v80
  v_mul_f32 v84, s93, v84
  v_cvt_pk_bf16_f32 v6, v80, v84
  v_lshlrev_b32 v80, 16, v6
  v_and_b32 v84, 0xffff0000, v6
  v_cvt_pk_bf16_f32 v6, v88, v92
  v_lshlrev_b32 v88, 16, v6
  v_and_b32 v92, 0xffff0000, v6
  v_mul_f32 v88, s93, v88
  v_mul_f32 v92, s93, v92
  v_cvt_pk_bf16_f32 v6, v88, v92
  v_lshlrev_b32 v88, 16, v6
  v_and_b32 v92, 0xffff0000, v6
  s_waitcnt vmcnt(14)
  v_dot2_f32_bf16 v96, v96, v2, 0
  v_dot2_f32_bf16 v100, v100, v2, 0
  v_dot2_f32_bf16 v65, v104, v2, 0
  v_dot2_f32_bf16 v69, v108, v2, 0
  v_dot2c_f32_bf16 v96, v97, v3
  v_dot2c_f32_bf16 v100, v101, v3
  v_dot2c_f32_bf16 v65, v105, v3
  v_dot2c_f32_bf16 v69, v109, v3
  v_dot2c_f32_bf16 v96, v98, v4
  v_dot2c_f32_bf16 v100, v102, v4
  v_dot2c_f32_bf16 v65, v106, v4
  v_dot2c_f32_bf16 v69, v110, v4
  v_dot2c_f32_bf16 v96, v99, v5
  v_dot2c_f32_bf16 v100, v103, v5
  v_dot2c_f32_bf16 v65, v107, v5
  v_dot2c_f32_bf16 v69, v111, v5
  v_add_f32_dpp v96, v96, v96 quad_perm:[1,0,3,2] row_mask:0xf bank_mask:0xf
  v_add_f32_dpp v100, v100, v100 quad_perm:[1,0,3,2] row_mask:0xf bank_mask:0xf
  v_add_f32_dpp v65, v65, v65 quad_perm:[1,0,3,2] row_mask:0xf bank_mask:0xf
  v_add_f32_dpp v69, v69, v69 quad_perm:[1,0,3,2] row_mask:0xf bank_mask:0xf
  v_add_f32_dpp v96, v96, v96 quad_perm:[2,3,0,1] row_mask:0xf bank_mask:0xf
  v_add_f32_dpp v100, v100, v100 quad_perm:[2,3,0,1] row_mask:0xf bank_mask:0xf
  v_add_f32_dpp v65, v65, v65 quad_perm:[2,3,0,1] row_mask:0xf bank_mask:0xf
  v_add_f32_dpp v69, v69, v69 quad_perm:[2,3,0,1] row_mask:0xf bank_mask:0xf
  v_add_f32_dpp v96, v96, v96 row_half_mirror row_mask:0xf bank_mask:0xf
  v_add_f32_dpp v100, v100, v100 row_half_mirror row_mask:0xf bank_mask:0xf
  v_add_f32_dpp v65, v65, v65 row_half_mirror row_mask:0xf bank_mask:0xf
  v_add_f32_dpp v69, v69, v69 row_half_mirror row_mask:0xf bank_mask:0xf
  v_add_f32_dpp v96, v96, v96 row_mirror row_mask:0xf bank_mask:0xf
  v_add_f32_dpp v100, v100, v100 row_mirror row_mask:0xf bank_mask:0xf
  v_add_f32_dpp v65, v65, v65 row_mirror row_mask:0xf bank_mask:0xf
  v_add_f32_dpp v69, v69, v69 row_mirror row_mask:0xf bank_mask:0xf
  v_cvt_pk_bf16_f32 v6, v96, v100
  v_lshlrev_b32 v96, 16, v6
  v_and_b32 v100, 0xffff0000, v6
  v_mul_f32 v96, s93, v96
  v_mul_f32 v100, s93, v100
  v_cvt_pk_bf16_f32 v6, v96, v100
  v_lshlrev_b32 v96, 16, v6
  v_and_b32 v100, 0xffff0000, v6
  v_cvt_pk_bf16_f32 v6, v65, v69
  v_lshlrev_b32 v65, 16, v6
  v_and_b32 v69, 0xffff0000, v6
  v_mul_f32 v65, s93, v65
  v_mul_f32 v69, s93, v69
  v_cvt_pk_bf16_f32 v6, v65, v69
  v_lshlrev_b32 v65, 16, v6
  v_and_b32 v69, 0xffff0000, v6
  s_add_u32 s6, s3, 10240
  s_and_b32 s6, s6, 0x3fff
  s_add_u32 s6, s6, s81
  buffer_load_dwordx4 v[104:107], v1, s[44:47], s6 offen nt
  s_add_u32 s6, s3, 11264
  s_and_b32 s6, s6, 0x3fff
  s_add_u32 s6, s6, s81
  buffer_load_dwordx4 v[108:111], v1, s[44:47], s6 offen nt
  s_waitcnt vmcnt(12)
  v_dot2_f32_bf16 v73, v112, v2, 0
  v_dot2_f32_bf16 v77, v116, v2, 0
  v_dot2_f32_bf16 v81, v120, v2, 0
  v_dot2_f32_bf16 v85, v124, v2, 0
  v_dot2c_f32_bf16 v73, v113, v3
  v_dot2c_f32_bf16 v77, v117, v3
  v_dot2c_f32_bf16 v81, v121, v3
  v_dot2c_f32_bf16 v85, v125, v3
  v_dot2c_f32_bf16 v73, v114, v4
  v_dot2c_f32_bf16 v77, v118, v4
  v_dot2c_f32_bf16 v81, v122, v4
  v_dot2c_f32_bf16 v85, v126, v4
  v_dot2c_f32_bf16 v73, v115, v5
  v_dot2c_f32_bf16 v77, v119, v5
  v_dot2c_f32_bf16 v81, v123, v5
  v_dot2c_f32_bf16 v85, v127, v5
  v_add_f32_dpp v73, v73, v73 quad_perm:[1,0,3,2] row_mask:0xf bank_mask:0xf
  v_add_f32_dpp v77, v77, v77 quad_perm:[1,0,3,2] row_mask:0xf bank_mask:0xf
  v_add_f32_dpp v81, v81, v81 quad_perm:[1,0,3,2] row_mask:0xf bank_mask:0xf
  v_add_f32_dpp v85, v85, v85 quad_perm:[1,0,3,2] row_mask:0xf bank_mask:0xf
  v_add_f32_dpp v73, v73, v73 quad_perm:[2,3,0,1] row_mask:0xf bank_mask:0xf
  v_add_f32_dpp v77, v77, v77 quad_perm:[2,3,0,1] row_mask:0xf bank_mask:0xf
  v_add_f32_dpp v81, v81, v81 quad_perm:[2,3,0,1] row_mask:0xf bank_mask:0xf
  v_add_f32_dpp v85, v85, v85 quad_perm:[2,3,0,1] row_mask:0xf bank_mask:0xf
  v_add_f32_dpp v73, v73, v73 row_half_mirror row_mask:0xf bank_mask:0xf
  v_add_f32_dpp v77, v77, v77 row_half_mirror row_mask:0xf bank_mask:0xf
  v_add_f32_dpp v81, v81, v81 row_half_mirror row_mask:0xf bank_mask:0xf
  v_add_f32_dpp v85, v85, v85 row_half_mirror row_mask:0xf bank_mask:0xf
  v_add_f32_dpp v73, v73, v73 row_mirror row_mask:0xf bank_mask:0xf
  v_add_f32_dpp v77, v77, v77 row_mirror row_mask:0xf bank_mask:0xf
  v_add_f32_dpp v81, v81, v81 row_mirror row_mask:0xf bank_mask:0xf
  v_add_f32_dpp v85, v85, v85 row_mirror row_mask:0xf bank_mask:0xf
  v_cvt_pk_bf16_f32 v6, v73, v77
  v_lshlrev_b32 v73, 16, v6
  v_and_b32 v77, 0xffff0000, v6
  v_mul_f32 v73, s93, v73
  v_mul_f32 v77, s93, v77
  v_cvt_pk_bf16_f32 v6, v73, v77
  v_lshlrev_b32 v73, 16, v6
  v_and_b32 v77, 0xffff0000, v6
  v_cvt_pk_bf16_f32 v6, v81, v85
  v_lshlrev_b32 v81, 16, v6
  v_and_b32 v85, 0xffff0000, v6
  v_mul_f32 v81, s93, v81
  v_mul_f32 v85, s93, v85
  v_cvt_pk_bf16_f32 v6, v81, v85
  v_lshlrev_b32 v81, 16, v6
  v_and_b32 v85, 0xffff0000, v6
  s_add_u32 s6, s3, 12288
  s_and_b32 s6, s6, 0x3fff
  s_add_u32 s6, s6, s81
  buffer_load_dwordx4 v[112:115], v1, s[44:47], s6 offen nt
  s_add_u32 s6, s3, 13312
  s_and_b32 s6, s6, 0x3fff
  s_add_u32 s6, s6, s81
  buffer_load_dwordx4 v[116:119], v1, s[44:47], s6 offen nt
  s_add_u32 s6, s3, 14336
  s_and_b32 s6, s6, 0x3fff
  s_add_u32 s6, s6, s81
  buffer_load_dwordx4 v[120:123], v1, s[44:47], s6 offen nt
  s_add_u32 s6, s3, 15360
  s_and_b32 s6, s6, 0x3fff
  s_add_u32 s6, s6, s81
  buffer_load_dwordx4 v[124:127], v1, s[44:47], s6 offen nt
  v_max3_f32 v6, v64, v68, v72
  v_max3_f32 v6, v6, v76, v80
  v_max3_f32 v6, v6, v84, v88
  v_max3_f32 v6, v6, v92, v96
  v_max3_f32 v6, v6, v100, v65
  v_max3_f32 v6, v6, v69, v73
  v_max3_f32 v6, v6, v77, v81
  v_max3_f32 v6, v6, v85, v19
  v_mov_b32 v7, v6
  s_nop 1
  v_permlane32_swap_b32 v6, v7
  v_max_f32 v6, v6, v7
  v_mov_b32 v7, v6
  s_nop 1
  v_permlane16_swap_b32 v6, v7
  v_max_f32 v6, v6, v7
  v_sub_f32 v8, v19, v6
  v_mul_f32 v8, s94, v8
  v_exp_f32 v8, v8
  v_mul_f32 v7, s94, v6
  v_mov_b32 v19, v6
  v_fma_f32 v64, v64, s94, -v7
  v_fma_f32 v68, v68, s94, -v7
  v_fma_f32 v72, v72, s94, -v7
  v_fma_f32 v76, v76, s94, -v7
  v_fma_f32 v80, v80, s94, -v7
  v_fma_f32 v84, v84, s94, -v7
  v_fma_f32 v88, v88, s94, -v7
  v_fma_f32 v92, v92, s94, -v7
  v_fma_f32 v96, v96, s94, -v7
  v_fma_f32 v100, v100, s94, -v7
  v_fma_f32 v65, v65, s94, -v7
  v_fma_f32 v69, v69, s94, -v7
  v_fma_f32 v73, v73, s94, -v7
  v_fma_f32 v77, v77, s94, -v7
  v_fma_f32 v81, v81, s94, -v7
  v_fma_f32 v85, v85, s94, -v7
  v_exp_f32 v64, v64
  v_exp_f32 v68, v68
  v_exp_f32 v72, v72
  v_exp_f32 v76, v76
  v_exp_f32 v80, v80
  v_exp_f32 v84, v84
  v_exp_f32 v88, v88
  v_exp_f32 v92, v92
  v_exp_f32 v96, v96
  v_exp_f32 v100, v100
  v_exp_f32 v65, v65
  v_exp_f32 v69, v69
  v_exp_f32 v73, v73
  v_exp_f32 v77, v77
  v_exp_f32 v81, v81
  v_exp_f32 v85, v85
  v_mul_f32 v10, v10, v8
  v_mul_f32 v11, v11, v8
  v_mul_f32 v12, v12, v8
  v_mul_f32 v13, v13, v8
  v_mul_f32 v14, v14, v8
  v_mul_f32 v15, v15, v8
  v_mul_f32 v16, v16, v8
  v_mul_f32 v17, v17, v8
  v_fma_f32 v20, v20, v8, v64
  v_add_f32 v9, v68, v72
  v_add_f32 v20, v20, v76
  v_add_f32 v9, v9, v80
  v_add_f32 v20, v20, v84
  v_add_f32 v9, v9, v88
  v_add_f32 v20, v20, v92
  v_add_f32 v9, v9, v96
  v_add_f32 v20, v20, v100
  v_add_f32 v9, v9, v65
  v_add_f32 v20, v20, v69
  v_add_f32 v9, v9, v73
  v_add_f32 v20, v20, v77
  v_add_f32 v9, v9, v81
  v_add_f32 v20, v20, v85
  v_add_f32 v20, v20, v9
  v_cvt_pk_bf16_f32 v2, v64, v68
  v_cvt_pk_bf16_f32 v3, v72, v76
  v_cvt_pk_bf16_f32 v4, v80, v84
  v_cvt_pk_bf16_f32 v5, v88, v92
  v_cvt_pk_bf16_f32 v6, v96, v100
  v_cvt_pk_bf16_f32 v7, v65, v69
  v_cvt_pk_bf16_f32 v8, v73, v77
  v_cvt_pk_bf16_f32 v9, v81, v85
  s_waitcnt vmcnt(14)
  v_perm_b32 v64, v28, v24, s86
  v_perm_b32 v65, v28, v24, s87
  v_dot2c_f32_bf16 v10, v64, v2
  v_dot2c_f32_bf16 v11, v65, v2
  v_perm_b32 v66, v29, v25, s86
  v_perm_b32 v67, v29, v25, s87
  v_dot2c_f32_bf16 v12, v66, v2
  v_dot2c_f32_bf16 v13, v67, v2
  v_perm_b32 v64, v30, v26, s86
  v_perm_b32 v65, v30, v26, s87
  v_dot2c_f32_bf16 v14, v64, v2
  v_dot2c_f32_bf16 v15, v65, v2
  v_perm_b32 v66, v31, v27, s86
  v_perm_b32 v67, v31, v27, s87
  v_dot2c_f32_bf16 v16, v66, v2
  v_dot2c_f32_bf16 v17, v67, v2
  s_waitcnt vmcnt(12)
  v_perm_b32 v64, v36, v32, s86
  v_perm_b32 v65, v36, v32, s87
  v_dot2c_f32_bf16 v10, v64, v3
  v_dot2c_f32_bf16 v11, v65, v3
  v_perm_b32 v66, v37, v33, s86
  v_perm_b32 v67, v37, v33, s87
  v_dot2c_f32_bf16 v12, v66, v3
  v_dot2c_f32_bf16 v13, v67, v3
  v_perm_b32 v64, v38, v34, s86
  v_perm_b32 v65, v38, v34, s87
  v_dot2c_f32_bf16 v14, v64, v3
  v_dot2c_f32_bf16 v15, v65, v3
  v_perm_b32 v66, v39, v35, s86
  v_perm_b32 v67, v39, v35, s87
  v_dot2c_f32_bf16 v16, v66, v3
  v_dot2c_f32_bf16 v17, v67, v3
  s_waitcnt vmcnt(10)
  v_perm_b32 v64, v44, v40, s86
  v_perm_b32 v65, v44, v40, s87
  v_dot2c_f32_bf16 v10, v64, v4
  v_dot2c_f32_bf16 v11, v65, v4
  v_perm_b32 v66, v45, v41, s86
  v_perm_b32 v67, v45, v41, s87
  v_dot2c_f32_bf16 v12, v66, v4
  v_dot2c_f32_bf16 v13, v67, v4
  v_perm_b32 v64, v46, v42, s86
  v_perm_b32 v65, v46, v42, s87
  v_dot2c_f32_bf16 v14, v64, v4
  v_dot2c_f32_bf16 v15, v65, v4
  v_perm_b32 v66, v47, v43, s86
  v_perm_b32 v67, v47, v43, s87
  v_dot2c_f32_bf16 v16, v66, v4
  v_dot2c_f32_bf16 v17, v67, v4
  s_waitcnt vmcnt(8)
  v_perm_b32 v64, v52, v48, s86
  v_perm_b32 v65, v52, v48, s87
  v_dot2c_f32_bf16 v10, v64, v5
  v_dot2c_f32_bf16 v11, v65, v5
  v_perm_b32 v66, v53, v49, s86
  v_perm_b32 v67, v53, v49, s87
  v_dot2c_f32_bf16 v12, v66, v5
  v_dot2c_f32_bf16 v13, v67, v5
  v_perm_b32 v64, v54, v50, s86
  v_perm_b32 v65, v54, v50, s87
  v_dot2c_f32_bf16 v14, v64, v5
  v_dot2c_f32_bf16 v15, v65, v5
  v_perm_b32 v66, v55, v51, s86
  v_perm_b32 v67, v55, v51, s87
  v_dot2c_f32_bf16 v16, v66, v5
  v_dot2c_f32_bf16 v17, v67, v5
  s_waitcnt vmcnt(6)
  v_perm_b32 v64, v60, v56, s86
  v_perm_b32 v65, v60, v56, s87
  v_dot2c_f32_bf16 v10, v64, v6
  v_dot2c_f32_bf16 v11, v65, v6
  v_perm_b32 v66, v61, v57, s86
  v_perm_b32 v67, v61, v57, s87
  v_dot2c_f32_bf16 v12, v66, v6
  v_dot2c_f32_bf16 v13, v67, v6
  v_perm_b32 v64, v62, v58, s86
  v_perm_b32 v65, v62, v58, s87
  v_dot2c_f32_bf16 v14, v64, v6
  v_dot2c_f32_bf16 v15, v65, v6
  v_perm_b32 v66, v63, v59, s86
  v_perm_b32 v67, v63, v59, s87
  v_dot2c_f32_bf16 v16, v66, v6
  v_dot2c_f32_bf16 v17, v67, v6
  s_waitcnt vmcnt(4)
  v_perm_b32 v64, v108, v104, s86
  v_perm_b32 v65, v108, v104, s87
  v_dot2c_f32_bf16 v10, v64, v7
  v_dot2c_f32_bf16 v11, v65, v7
  v_perm_b32 v66, v109, v105, s86
  v_perm_b32 v67, v109, v105, s87
  v_dot2c_f32_bf16 v12, v66, v7
  v_dot2c_f32_bf16 v13, v67, v7
  v_perm_b32 v64, v110, v106, s86
  v_perm_b32 v65, v110, v106, s87
  v_dot2c_f32_bf16 v14, v64, v7
  v_dot2c_f32_bf16 v15, v65, v7
  v_perm_b32 v66, v111, v107, s86
  v_perm_b32 v67, v111, v107, s87
  v_dot2c_f32_bf16 v16, v66, v7
  v_dot2c_f32_bf16 v17, v67, v7
  s_waitcnt vmcnt(2)
  v_perm_b32 v64, v116, v112, s86
  v_perm_b32 v65, v116, v112, s87
  v_dot2c_f32_bf16 v10, v64, v8
  v_dot2c_f32_bf16 v11, v65, v8
  v_perm_b32 v66, v117, v113, s86
  v_perm_b32 v67, v117, v113, s87
  v_dot2c_f32_bf16 v12, v66, v8
  v_dot2c_f32_bf16 v13, v67, v8
  v_perm_b32 v64, v118, v114, s86
  v_perm_b32 v65, v118, v114, s87
  v_dot2c_f32_bf16 v14, v64, v8
  v_dot2c_f32_bf16 v15, v65, v8
  v_perm_b32 v66, v119, v115, s86
  v_perm_b32 v67, v119, v115, s87
  v_dot2c_f32_bf16 v16, v66, v8
  v_dot2c_f32_bf16 v17, v67, v8
  s_waitcnt vmcnt(0)
  v_perm_b32 v64, v124, v120, s86
  v_perm_b32 v65, v124, v120, s87
  v_dot2c_f32_bf16 v10, v64, v9
  v_dot2c_f32_bf16 v11, v65, v9
  v_perm_b32 v66, v125, v121, s86
  v_perm_b32 v67, v125, v121, s87
  v_dot2c_f32_bf16 v12, v66, v9
  v_dot2c_f32_bf16 v13, v67, v9
  v_perm_b32 v64, v126, v122, s86
  v_perm_b32 v65, v126, v122, s87
  v_dot2c_f32_bf16 v14, v64, v9
  v_dot2c_f32_bf16 v15, v65, v9
  v_perm_b32 v66, v127, v123, s86
  v_perm_b32 v67, v127, v123, s87
  v_dot2c_f32_bf16 v16, v66, v9
  v_dot2c_f32_bf16 v17, v67, v9
  s_branch L_done
L_claim0:
  v_mov_b32 v6, 0
L_qwaitb:
  ds_read_b32 v2, v6 offset:8576
  s_waitcnt lgkmcnt(0)
  v_readfirstlane_b32 s6, v2
  s_cmp_eq_u32 s6, 1
  s_cbranch_scc1 L_qokb
  s_add_u32 s88, s88, 1
  s_cmp_gt_u32 s88, 0x40000
  s_cbranch_scc1 L_qokb
  s_sleep 2
  s_branch L_qwaitb
L_qokb:
  s_cmp_eq_u32 s76, 0
  s_cbranch_scc0 L_ccd
  v_and_b32 v6, 31, v0
  v_lshlrev_b32 v6, 3, v6
L_cc:
  buffer_load_dword v23, v6, s[68:71], 0 offen sc1
  s_waitcnt vmcnt(0)
  v_and_b32 v23, 0xffff, v23
  v_cmp_gt_u32 vcc, 8, v23
  s_cbranch_vccz L_ccd
  s_add_u32 s88, s88, 1
  s_cmp_gt_u32 s88, 0x40000
  s_cbranch_scc1 L_ccd
  s_sleep 16
  s_branch L_cc
L_ccd:
  s_setprio 0
  v_mov_b32 v23, 1
  s_mov_b64 exec, 1
  buffer_atomic_add v23, off, s[52:55], s96 sc0 sc1
  s_mov_b64 exec, -1
  s_branch L_next
L_small:
  s_add_u32 s6, s3, 0
  s_and_b32 s6, s6, 0x1fff
  s_add_u32 s6, s6, s81
  buffer_load_dwordx4 v[64:67], v1, s[40:43], s6 offen nt
  s_add_u32 s6, s3, 1024
  s_and_b32 s6, s6, 0x1fff
  s_add_u32 s6, s6, s81
  buffer_load_dwordx4 v[68:71], v1, s[40:43], s6 offen nt
  s_add_u32 s6, s3, 2048
  s_and_b32 s6, s6, 0x1fff
  s_add_u32 s6, s6, s81
  buffer_load_dwordx4 v[72:75], v1, s[40:43], s6 offen nt
  s_add_u32 s6, s3, 3072
  s_and_b32 s6, s6, 0x1fff
  s_add_u32 s6, s6, s81
  buffer_load_dwordx4 v[76:79], v1, s[40:43], s6 offen nt
  s_add_u32 s6, s3, 4096
  s_and_b32 s6, s6, 0x1fff
  s_add_u32 s6, s6, s81
  buffer_load_dwordx4 v[80:83], v1, s[40:43], s6 offen nt
  s_add_u32 s6, s3, 5120
  s_and_b32 s6, s6, 0x1fff
  s_add_u32 s6, s6, s81
  buffer_load_dwordx4 v[84:87], v1, s[40:43], s6 offen nt
  s_add_u32 s6, s3, 6144
  s_and_b32 s6, s6, 0x1fff
  s_add_u32 s6, s6, s81
  buffer_load_dwordx4 v[88:91], v1, s[40:43], s6 offen nt
  s_add_u32 s6, s3, 7168
  s_and_b32 s6, s6, 0x1fff
  s_add_u32 s6, s6, s81
  buffer_load_dwordx4 v[92:95], v1, s[40:43], s6 offen nt
  s_add_u32 s6, s3, 0
  s_and_b32 s6, s6, 0x1fff
  s_add_u32 s6, s6, s81
  buffer_load_dwordx4 v[24:27], v1, s[44:47], s6 offen nt
  s_add_u32 s6, s3, 1024
  s_and_b32 s6, s6, 0x1fff
  s_add_u32 s6, s6, s81
  buffer_load_dwordx4 v[28:31], v1, s[44:47], s6 offen nt
  s_add_u32 s6, s3, 2048
  s_and_b32 s6, s6, 0x1fff
  s_add_u32 s6, s6, s81
  buffer_load_dwordx4 v[32:35], v1, s[44:47], s6 offen nt
  s_add_u32 s6, s3, 3072
  s_and_b32 s6, s6, 0x1fff
  s_add_u32 s6, s6, s81
  buffer_load_dwordx4 v[36:39], v1, s[44:47], s6 offen nt
  s_add_u32 s6, s3, 4096
  s_and_b32 s6, s6, 0x1fff
  s_add_u32 s6, s6, s81
  buffer_load_dwordx4 v[40:43], v1, s[44:47], s6 offen nt
  s_add_u32 s6, s3, 5120
  s_and_b32 s6, s6, 0x1fff
  s_add_u32 s6, s6, s81
  buffer_load_dwordx4 v[44:47], v1, s[44:47], s6 offen nt
  s_add_u32 s6, s3, 6144
  s_and_b32 s6, s6, 0x1fff
  s_add_u32 s6, s6, s81
  buffer_load_dwordx4 v[48:51], v1, s[44:47], s6 offen nt
  s_add_u32 s6, s3, 7168
  s_and_b32 s6, s6, 0x1fff
  s_add_u32 s6, s6, s81
  buffer_load_dwordx4 v[52:55], v1, s[44:47], s6 offen nt
  s_setprio 0
  v_mov_b32 v23, 1
  s_mov_b64 exec, 1
  buffer_atomic_add v23, off, s[52:55], s96 sc0 sc1
  s_mov_b64 exec, -1
  v_and_b32 v6, 15, v0
  v_lshlrev_b32 v6, 4, v6
  ds_read_b128 v[2:5], v6 offset:8192
  s_waitcnt lgkmcnt(0)
  s_waitcnt vmcnt(13)
  v_dot2_f32_bf16 v64, v64, v2, 0
  v_dot2_f32_bf16 v68, v68, v2, 0
  v_dot2_f32_bf16 v72, v72, v2, 0
  v_dot2_f32_bf16 v76, v76, v2, 0
  v_dot2c_f32_bf16 v64, v65, v3
  v_dot2c_f32_bf16 v68, v69, v3
  v_dot2c_f32_bf16 v72, v73, v3
  v_dot2c_f32_bf16 v76, v77, v3
  v_dot2c_f32_bf16 v64, v66, v4
  v_dot2c_f32_bf16 v68, v70, v4
  v_dot2c_f32_bf16 v72, v74, v4
  v_dot2c_f32_bf16 v76, v78, v4
  v_dot2c_f32_bf16 v64, v67, v5
  v_dot2c_f32_bf16 v68, v71, v5
  v_dot2c_f32_bf16 v72, v75, v5
  v_dot2c_f32_bf16 v76, v79, v5
  v_add_f32_dpp v64, v64, v64 quad_perm:[1,0,3,2] row_mask:0xf bank_mask:0xf
  v_add_f32_dpp v68, v68, v68 quad_perm:[1,0,3,2] row_mask:0xf bank_mask:0xf
  v_add_f32_dpp v72, v72, v72 quad_perm:[1,0,3,2] row_mask:0xf bank_mask:0xf
  v_add_f32_dpp v76, v76, v76 quad_perm:[1,0,3,2] row_mask:0xf bank_mask:0xf
  v_add_f32_dpp v64, v64, v64 quad_perm:[2,3,0,1] row_mask:0xf bank_mask:0xf
  v_add_f32_dpp v68, v68, v68 quad_perm:[2,3,0,1] row_mask:0xf bank_mask:0xf
  v_add_f32_dpp v72, v72, v72 quad_perm:[2,3,0,1] row_mask:0xf bank_mask:0xf
  v_add_f32_dpp v76, v76, v76 quad_perm:[2,3,0,1] row_mask:0xf bank_mask:0xf
  v_add_f32_dpp v64, v64, v64 row_half_mirror row_mask:0xf bank_mask:0xf
  v_add_f32_dpp v68, v68, v68 row_half_mirror row_mask:0xf bank_mask:0xf
  v_add_f32_dpp v72, v72, v72 row_half_mirror row_mask:0xf bank_mask:0xf
  v_add_f32_dpp v76, v76, v76 row_half_mirror row_mask:0xf bank_mask:0xf
  v_add_f32_dpp v64, v64, v64 row_mirror row_mask:0xf bank_mask:0xf
  v_add_f32_dpp v68, v68, v68 row_mirror row_mask:0xf bank_mask:0xf
  v_add_f32_dpp v72, v72, v72 row_mirror row_mask:0xf bank_mask:0xf
  v_add_f32_dpp v76, v76, v76 row_mirror row_mask:0xf bank_mask:0xf
  v_cvt_pk_bf16_f32 v6, v64, v68
  v_lshlrev_b32 v64, 16, v6
  v_and_b32 v68, 0xffff0000, v6
  v_mul_f32 v64, s93, v64
  v_mul_f32 v68, s93, v68
  v_cvt_pk_bf16_f32 v6, v64, v68
  v_lshlrev_b32 v64, 16, v6
  v_and_b32 v68, 0xffff0000, v6
  v_cvt_pk_bf16_f32 v6, v72, v76
  v_lshlrev_b32 v72, 16, v6
  v_and_b32 v76, 0xffff0000, v6
  v_mul_f32 v72, s93, v72
  v_mul_f32 v76, s93, v76
  v_cvt_pk_bf16_f32 v6, v72, v76
  v_lshlrev_b32 v72, 16, v6
  v_and_b32 v76, 0xffff0000, v6
  s_waitcnt vmcnt(9)
  v_dot2_f32_bf16 v80, v80, v2, 0
  v_dot2_f32_bf16 v84, v84, v2, 0
  v_dot2_f32_bf16 v88, v88, v2, 0
  v_dot2_f32_bf16 v92, v92, v2, 0
  v_dot2c_f32_bf16 v80, v81, v3
  v_dot2c_f32_bf16 v84, v85, v3
  v_dot2c_f32_bf16 v88, v89, v3
  v_dot2c_f32_bf16 v92, v93, v3
  v_dot2c_f32_bf16 v80, v82, v4
  v_dot2c_f32_bf16 v84, v86, v4
  v_dot2c_f32_bf16 v88, v90, v4
  v_dot2c_f32_bf16 v92, v94, v4
  v_dot2c_f32_bf16 v80, v83, v5
  v_dot2c_f32_bf16 v84, v87, v5
  v_dot2c_f32_bf16 v88, v91, v5
  v_dot2c_f32_bf16 v92, v95, v5
  v_add_f32_dpp v80, v80, v80 quad_perm:[1,0,3,2] row_mask:0xf bank_mask:0xf
  v_add_f32_dpp v84, v84, v84 quad_perm:[1,0,3,2] row_mask:0xf bank_mask:0xf
  v_add_f32_dpp v88, v88, v88 quad_perm:[1,0,3,2] row_mask:0xf bank_mask:0xf
  v_add_f32_dpp v92, v92, v92 quad_perm:[1,0,3,2] row_mask:0xf bank_mask:0xf
  v_add_f32_dpp v80, v80, v80 quad_perm:[2,3,0,1] row_mask:0xf bank_mask:0xf
  v_add_f32_dpp v84, v84, v84 quad_perm:[2,3,0,1] row_mask:0xf bank_mask:0xf
  v_add_f32_dpp v88, v88, v88 quad_perm:[2,3,0,1] row_mask:0xf bank_mask:0xf
  v_add_f32_dpp v92, v92, v92 quad_perm:[2,3,0,1] row_mask:0xf bank_mask:0xf
  v_add_f32_dpp v80, v80, v80 row_half_mirror row_mask:0xf bank_mask:0xf
  v_add_f32_dpp v84, v84, v84 row_half_mirror row_mask:0xf bank_mask:0xf
  v_add_f32_dpp v88, v88, v88 row_half_mirror row_mask:0xf bank_mask:0xf
  v_add_f32_dpp v92, v92, v92 row_half_mirror row_mask:0xf bank_mask:0xf
  v_add_f32_dpp v80, v80, v80 row_mirror row_mask:0xf bank_mask:0xf
  v_add_f32_dpp v84, v84, v84 row_mirror row_mask:0xf bank_mask:0xf
  v_add_f32_dpp v88, v88, v88 row_mirror row_mask:0xf bank_mask:0xf
  v_add_f32_dpp v92, v92, v92 row_mirror row_mask:0xf bank_mask:0xf
  v_cvt_pk_bf16_f32 v6, v80, v84
  v_lshlrev_b32 v80, 16, v6
  v_and_b32 v84, 0xffff0000, v6
  v_mul_f32 v80, s93, v80
  v_mul_f32 v84, s93, v84
  v_cvt_pk_bf16_f32 v6, v80, v84
  v_lshlrev_b32 v80, 16, v6
  v_and_b32 v84, 0xffff0000, v6
  v_cvt_pk_bf16_f32 v6, v88, v92
  v_lshlrev_b32 v88, 16, v6
  v_and_b32 v92, 0xffff0000, v6
  v_mul_f32 v88, s93, v88
  v_mul_f32 v92, s93, v92
  v_cvt_pk_bf16_f32 v6, v88, v92
  v_lshlrev_b32 v88, 16, v6
  v_and_b32 v92, 0xffff0000, v6
  v_max3_f32 v6, v64, v68, v72
  v_max3_f32 v6, v6, v76, v80
  v_max3_f32 v6, v6, v84, v88
  v_max3_f32 v6, v6, v92, v19
  v_mov_b32 v7, v6
  s_nop 1
  v_permlane32_swap_b32 v6, v7
  v_max_f32 v6, v6, v7
  v_mov_b32 v7, v6
  s_nop 1
  v_permlane16_swap_b32 v6, v7
  v_max_f32 v6, v6, v7
  v_sub_f32 v8, v19, v6
  v_mul_f32 v8, s94, v8
  v_exp_f32 v8, v8
  v_mul_f32 v7, s94, v6
  v_mov_b32 v19, v6
  v_fma_f32 v64, v64, s94, -v7
  v_fma_f32 v68, v68, s94, -v7
  v_fma_f32 v72, v72, s94, -v7
  v_fma_f32 v76, v76, s94, -v7
  v_fma_f32 v80, v80, s94, -v7
  v_fma_f32 v84, v84, s94, -v7
  v_fma_f32 v88, v88, s94, -v7
  v_fma_f32 v92, v92, s94, -v7
  v_exp_f32 v64, v64
  v_exp_f32 v68, v68
  v_exp_f32 v72, v72
  v_exp_f32 v76, v76
  v_exp_f32 v80, v80
  v_exp_f32 v84, v84
  v_exp_f32 v88, v88
  v_exp_f32 v92, v92
  v_mul_f32 v10, v10, v8
  v_mul_f32 v11, v11, v8
  v_mul_f32 v12, v12, v8
  v_mul_f32 v13, v13, v8
  v_mul_f32 v14, v14, v8
  v_mul_f32 v15, v15, v8
  v_mul_f32 v16, v16, v8
  v_mul_f32 v17, v17, v8
  v_fma_f32 v20, v20, v8, v64
  v_add_f32 v9, v68, v72
  v_add_f32 v20, v20, v76
  v_add_f32 v9, v9, v80
  v_add_f32 v20, v20, v84
  v_add_f32 v9, v9, v88
  v_add_f32 v20, v20, v92
  v_add_f32 v20, v20, v9
  v_cvt_pk_bf16_f32 v2, v64, v68
  v_cvt_pk_bf16_f32 v3, v72, v76
  v_cvt_pk_bf16_f32 v4, v80, v84
  v_cvt_pk_bf16_f32 v5, v88, v92
  s_waitcnt vmcnt(7)
  v_perm_b32 v64, v28, v24, s86
  v_perm_b32 v65, v28, v24, s87
  v_dot2c_f32_bf16 v10, v64, v2
  v_dot2c_f32_bf16 v11, v65, v2
  v_perm_b32 v66, v29, v25, s86
  v_perm_b32 v67, v29, v25, s87
  v_dot2c_f32_bf16 v12, v66, v2
  v_dot2c_f32_bf16 v13, v67, v2
  v_perm_b32 v64, v30, v26, s86
  v_perm_b32 v65, v30, v26, s87
  v_dot2c_f32_bf16 v14, v64, v2
  v_dot2c_f32_bf16 v15, v65, v2
  v_perm_b32 v66, v31, v27, s86
  v_perm_b32 v67, v31, v27, s87
  v_dot2c_f32_bf16 v16, v66, v2
  v_dot2c_f32_bf16 v17, v67, v2
  s_waitcnt vmcnt(5)
  v_perm_b32 v64, v36, v32, s86
  v_perm_b32 v65, v36, v32, s87
  v_dot2c_f32_bf16 v10, v64, v3
  v_dot2c_f32_bf16 v11, v65, v3
  v_perm_b32 v66, v37, v33, s86
  v_perm_b32 v67, v37, v33, s87
  v_dot2c_f32_bf16 v12, v66, v3
  v_dot2c_f32_bf16 v13, v67, v3
  v_perm_b32 v64, v38, v34, s86
  v_perm_b32 v65, v38, v34, s87
  v_dot2c_f32_bf16 v14, v64, v3
  v_dot2c_f32_bf16 v15, v65, v3
  v_perm_b32 v66, v39, v35, s86
  v_perm_b32 v67, v39, v35, s87
  v_dot2c_f32_bf16 v16, v66, v3
  v_dot2c_f32_bf16 v17, v67, v3
  s_waitcnt vmcnt(3)
  v_perm_b32 v64, v44, v40, s86
  v_perm_b32 v65, v44, v40, s87
  v_dot2c_f32_bf16 v10, v64, v4
  v_dot2c_f32_bf16 v11, v65, v4
  v_perm_b32 v66, v45, v41, s86
  v_perm_b32 v67, v45, v41, s87
  v_dot2c_f32_bf16 v12, v66, v4
  v_dot2c_f32_bf16 v13, v67, v4
  v_perm_b32 v64, v46, v42, s86
  v_perm_b32 v65, v46, v42, s87
  v_dot2c_f32_bf16 v14, v64, v4
  v_dot2c_f32_bf16 v15, v65, v4
  v_perm_b32 v66, v47, v43, s86
  v_perm_b32 v67, v47, v43, s87
  v_dot2c_f32_bf16 v16, v66, v4
  v_dot2c_f32_bf16 v17, v67, v4
  s_waitcnt vmcnt(1)
  v_perm_b32 v64, v52, v48, s86
  v_perm_b32 v65, v52, v48, s87
  v_dot2c_f32_bf16 v10, v64, v5
  v_dot2c_f32_bf16 v11, v65, v5
  v_perm_b32 v66, v53, v49, s86
  v_perm_b32 v67, v53, v49, s87
  v_dot2c_f32_bf16 v12, v66, v5
  v_dot2c_f32_bf16 v13, v67, v5
  v_perm_b32 v64, v54, v50, s86
  v_perm_b32 v65, v54, v50, s87
  v_dot2c_f32_bf16 v14, v64, v5
  v_dot2c_f32_bf16 v15, v65, v5
  v_perm_b32 v66, v55, v51, s86
  v_perm_b32 v67, v55, v51, s87
  v_dot2c_f32_bf16 v16, v66, v5
  v_dot2c_f32_bf16 v17, v67, v5
L_next:
  s_waitcnt vmcnt(0)
  v_readfirstlane_b32 s6, v23
  s_nop 1
  s_cmp_lt_u32 s6, 32
  s_cbranch_scc0 L_done
  s_add_u32 s6, s6, 96
  s_lshl_b32 s6, s6, 13
  s_lshl_b32 s81, s95, 20
  s_add_u32 s81, s81, s6
  s_branch L_small
L_idle:
  s_waitcnt vmcnt(0)
L_done:
  s_setprio 1
  v_mov_b32 v6, v20
  s_nop 1
  v_permlane32_swap_b32 v20, v6
  v_add_f32 v20, v20, v6
  v_mov_b32 v6, v20
  s_nop 1
  v_permlane16_swap_b32 v20, v6
  v_add_f32 v20, v20, v6
  s_lshl_b32 s6, s76, 3
  v_mov_b32 v6, s6
  v_mov_b32 v8, v19
  v_mov_b32 v9, v20
  s_mov_b64 exec, 1
  ds_write_b64 v6, v[8:9] offset:8448
  s_mov_b64 exec, -1
  s_nop 2
  v_permlane32_swap_b32 v10, v14
  v_permlane32_swap_b32 v11, v15
  v_permlane32_swap_b32 v12, v16
  v_permlane32_swap_b32 v13, v17
  v_add_f32 v10, v10, v14
  v_add_f32 v11, v11, v15
  v_add_f32 v12, v12, v16
  v_add_f32 v13, v13, v17
  s_nop 0
  v_permlane16_swap_b32 v10, v12
  v_permlane16_swap_b32 v11, v13
  v_add_f32 v10, v10, v12
  v_add_f32 v11, v11, v13
  ds_write_b64 v21, v[10:11] offset:0
  s_waitcnt lgkmcnt(0)
  s_barrier
  s_cmp_eq_u32 s76, 0
  s_cbranch_scc0 L_t1
  v_and_b32 v14, 15, v0
  v_lshlrev_b32 v14, 3, v14
  ds_read_b64 v[16:17], v14 offset:8448
  v_and_b32 v2, 31, v0
  v_lshlrev_b32 v2, 4, v2
  v_lshrrev_b32 v3, 5, v0
  v_lshl_add_u32 v4, v3, 12, v2
  ds_read_b128 v[24:27], v4 offset:0
  ds_read_b128 v[28:31], v4 offset:512
  ds_read_b128 v[32:35], v4 offset:1024
  ds_read_b128 v[36:39], v4 offset:1536
  ds_read_b128 v[40:43], v4 offset:2048
  ds_read_b128 v[44:47], v4 offset:2560
  ds_read_b128 v[48:51], v4 offset:3072
  ds_read_b128 v[52:55], v4 offset:3584
  s_waitcnt lgkmcnt(8)
  v_mov_b32 v19, v16
  s_nop 1
  v_max_f32_dpp v19, v19, v19 quad_perm:[1,0,3,2] row_mask:0xf bank_mask:0xf
  s_nop 1
  v_max_f32_dpp v19, v19, v19 quad_perm:[2,3,0,1] row_mask:0xf bank_mask:0xf
  s_nop 1
  v_max_f32_dpp v19, v19, v19 row_half_mirror row_mask:0xf bank_mask:0xf
  s_nop 1
  v_max_f32_dpp v19, v19, v19 row_mirror row_mask:0xf bank_mask:0xf
  v_sub_f32 v16, v16, v19
  v_mul_f32 v16, s94, v16
  v_exp_f32 v16, v16
  s_nop 0
  v_mul_f32 v20, v16, v17
  s_nop 1
  v_add_f32_dpp v20, v20, v20 quad_perm:[1,0,3,2] row_mask:0xf bank_mask:0xf
  s_nop 1
  v_add_f32_dpp v20, v20, v20 quad_perm:[2,3,0,1] row_mask:0xf bank_mask:0xf
  s_nop 1
  v_add_f32_dpp v20, v20, v20 row_half_mirror row_mask:0xf bank_mask:0xf
  s_nop 1
  v_add_f32_dpp v20, v20, v20 row_mirror row_mask:0xf bank_mask:0xf
  v_mov_b32 v17, v16
  s_nop 1
  v_mov_b32_dpp v17, v16 row_ror:8 row_mask:0xc bank_mask:0xf
  s_nop 1
  v_mov_b32_dpp v56, v17 row_newbcast:0 row_mask:0xf bank_mask:0xf
  v_mov_b32_dpp v57, v17 row_newbcast:1 row_mask:0xf bank_mask:0xf
  v_mov_b32_dpp v58, v17 row_newbcast:2 row_mask:0xf bank_mask:0xf
  v_mov_b32_dpp v59, v17 row_newbcast:3 row_mask:0xf bank_mask:0xf
  v_mov_b32_dpp v60, v17 row_newbcast:4 row_mask:0xf bank_mask:0xf
  v_mov_b32_dpp v61, v17 row_newbcast:5 row_mask:0xf bank_mask:0xf
  v_mov_b32_dpp v62, v17 row_newbcast:6 row_mask:0xf bank_mask:0xf
  v_mov_b32_dpp v63, v17 row_newbcast:7 row_mask:0xf bank_mask:0xf
  s_waitcnt lgkmcnt(0)
  v_mul_f32 v24, v24, v56
  v_mul_f32 v25, v25, v56
  v_mul_f32 v26, v26, v56
  v_mul_f32 v27, v27, v56
  v_fmac_f32 v24, v28, v57
  v_fmac_f32 v25, v29, v57
  v_fmac_f32 v26, v30, v57
  v_fmac_f32 v27, v31, v57
  v_fmac_f32 v24, v32, v58
  v_fmac_f32 v25, v33, v58
  v_fmac_f32 v26, v34, v58
  v_fmac_f32 v27, v35, v58
  v_fmac_f32 v24, v36, v59
  v_fmac_f32 v25, v37, v59
  v_fmac_f32 v26, v38, v59
  v_fmac_f32 v27, v39, v59
  v_fmac_f32 v24, v40, v60
  v_fmac_f32 v25, v41, v60
  v_fmac_f32 v26, v42, v60
  v_fmac_f32 v27, v43, v60
  v_fmac_f32 v24, v44, v61
  v_fmac_f32 v25, v45, v61
  v_fmac_f32 v26, v46, v61
  v_fmac_f32 v27, v47, v61
  v_fmac_f32 v24, v48, v62
  v_fmac_f32 v25, v49, v62
  v_fmac_f32 v26, v50, v62
  v_fmac_f32 v27, v51, v62
  v_fmac_f32 v24, v52, v63
  v_fmac_f32 v25, v53, v63
  v_fmac_f32 v26, v54, v63
  v_fmac_f32 v27, v55, v63
  s_nop 1
  v_permlane32_swap_b32 v24, v26
  v_permlane32_swap_b32 v25, v27
  v_add_f32 v24, v24, v26
  v_add_f32 v25, v25, v27
  v_lshl_add_u32 v2, v3, 3, v2
  s_lshl_b32 s6, s77, 12
  s_lshl_b32 s7, s80, 9
  s_add_u32 s6, s6, s7
  s_add_u32 s6, s6, 65536
  buffer_store_dwordx2 v[24:25], v2, s[52:55], s6 offen sc1
  v_mov_b32 v16, v19
  v_mov_b32 v17, v20
  s_lshl_b32 s6, s77, 7
  s_lshl_b32 s7, s80, 3
  s_add_u32 s6, s6, s7
  s_add_u32 s6, s6, 0
  s_mov_b64 exec, 1
  buffer_store_dwordx2 v[16:17], v1, s[52:55], s6 offen sc1
  s_barrier
  s_endpgm
L_t1:
  s_barrier
  s_cmp_eq_u32 s76, 7
  s_cbranch_scc0 L_t1b
  v_lshrrev_b32 v4, 5, v0
  v_and_b32 v5, 31, v0
  v_lshlrev_b32 v6, 11, v4
  v_lshl_add_u32 v6, v5, 4, v6
  v_lshlrev_b32 v7, 5, v4
  s_lshl_b32 s8, s77, 12
  s_add_u32 s8, s8, 65536
  s_lshl_b32 s9, s77, 7
  s_add_u32 s9, s9, 0
  v_lshlrev_b32 v12, 8, v4
  v_lshl_add_u32 v12, v5, 3, v12
L_ypoll:
  buffer_load_dwordx4 v[48:51], v6, s[52:55], s8 offen offset:0 sc1
  buffer_load_dwordx4 v[52:55], v6, s[52:55], s8 offen offset:512 sc1
  buffer_load_dwordx4 v[56:59], v6, s[52:55], s8 offen offset:1024 sc1
  buffer_load_dwordx4 v[60:63], v6, s[52:55], s8 offen offset:1536 sc1
  buffer_load_dwordx4 v[64:67], v7, s[52:55], s9 offen offset:0 sc1
  buffer_load_dwordx4 v[68:71], v7, s[52:55], s9 offen offset:16 sc1
  s_waitcnt vmcnt(5)
  v_max3_u32 v22, v48, v49, v50
  v_max_u32 v22, v22, v51
  s_waitcnt vmcnt(4)
  v_max3_u32 v23, v52, v53, v54
  v_max_u32 v23, v23, v55
  s_waitcnt vmcnt(3)
  v_max3_u32 v22, v22, v56, v57
  v_max3_u32 v22, v22, v58, v59
  s_waitcnt vmcnt(2)
  v_max3_u32 v23, v23, v60, v61
  v_max3_u32 v23, v23, v62, v63
  s_waitcnt vmcnt(1)
  v_max3_u32 v22, v22, v64, v65
  v_max3_u32 v22, v22, v66, v67
  s_waitcnt vmcnt(0)
  v_max3_u32 v23, v23, v68, v69
  v_max3_u32 v23, v23, v70, v71
  v_max_u32 v22, v22, v23
  v_cmp_eq_u32 vcc, -1, v22
  s_cbranch_vccz L_ygo
  s_mov_b64 exec, vcc
  s_add_u32 s88, s88, 1
  s_cmp_gt_u32 s88, 0x40000
  s_cbranch_scc1 L_ygo
  s_branch L_ypoll
L_ygo:
  s_mov_b64 exec, -1
  v_max3_f32 v8, v64, v66, v68
  v_max_f32 v8, v8, v70
  v_sub_f32 v64, v64, v8
  v_mul_f32 v64, s94, v64
  v_exp_f32 v64, v64
  v_sub_f32 v66, v66, v8
  v_mul_f32 v66, s94, v66
  v_exp_f32 v66, v66
  v_sub_f32 v68, v68, v8
  v_mul_f32 v68, s94, v68
  v_exp_f32 v68, v68
  v_sub_f32 v70, v70, v8
  v_mul_f32 v70, s94, v70
  v_exp_f32 v70, v70
  s_nop 0
  v_mul_f32 v9, v64, v65
  v_fmac_f32 v9, v66, v67
  v_fmac_f32 v9, v68, v69
  v_fmac_f32 v9, v70, v71
  v_rcp_f32 v9, v9
  v_mul_f32 v48, v64, v48
  v_mul_f32 v49, v64, v49
  v_mul_f32 v50, v64, v50
  v_mul_f32 v51, v64, v51
  v_fmac_f32 v48, v66, v52
  v_fmac_f32 v49, v66, v53
  v_fmac_f32 v50, v66, v54
  v_fmac_f32 v51, v66, v55
  v_fmac_f32 v48, v68, v56
  v_fmac_f32 v49, v68, v57
  v_fmac_f32 v50, v68, v58
  v_fmac_f32 v51, v68, v59
  v_fmac_f32 v48, v70, v60
  v_fmac_f32 v49, v70, v61
  v_fmac_f32 v50, v70, v62
  v_fmac_f32 v51, v70, v63
  v_mul_f32 v48, v9, v48
  v_mul_f32 v49, v9, v49
  v_mul_f32 v50, v9, v50
  v_mul_f32 v51, v9, v51
  v_cvt_pk_bf16_f32 v10, v48, v49
  v_cvt_pk_bf16_f32 v11, v50, v51
  ds_write_b64 v12, v[10:11] offset:8704
  s_waitcnt lgkmcnt(0)
  s_barrier
  s_endpgm
L_t1b:
  s_cmp_lt_u32 s76, 5
  s_cbranch_scc0 L_t2
  s_cmp_lt_u32 s80, 5
  s_cbranch_scc0 L_end
  s_sub_u32 s15, s76, 1
  v_lshrrev_b32 v2, 4, v0
  v_bfe_u32 v3, v0, 2, 2
  v_lshl_add_u32 v3, v2, 3, v3
  v_lshlrev_b32 v3, 8, v3
  v_and_b32 v4, 3, v0
  v_lshl_add_u32 v3, v4, 3, v3
  s_lshl_b32 s6, s15, 6
  v_add_u32 v3, s6, v3
  ds_read_b64_tr_b16 v[32:33], v3 offset:16384
  ds_read_b64_tr_b16 v[34:35], v3 offset:17408
  ds_read_b64_tr_b16 v[36:37], v3 offset:24576
  ds_read_b64_tr_b16 v[38:39], v3 offset:25600
  ds_read_b64_tr_b16 v[40:41], v3 offset:32768
  ds_read_b64_tr_b16 v[42:43], v3 offset:33792
  ds_read_b64_tr_b16 v[44:45], v3 offset:40960
  ds_read_b64_tr_b16 v[46:47], v3 offset:41984
  ds_read_b64_tr_b16 v[48:49], v3 offset:16416
  ds_read_b64_tr_b16 v[50:51], v3 offset:17440
  ds_read_b64_tr_b16 v[52:53], v3 offset:24608
  ds_read_b64_tr_b16 v[54:55], v3 offset:25632
  ds_read_b64_tr_b16 v[56:57], v3 offset:32800
  ds_read_b64_tr_b16 v[58:59], v3 offset:33824
  ds_read_b64_tr_b16 v[60:61], v3 offset:40992
  ds_read_b64_tr_b16 v[62:63], v3 offset:42016
  v_and_b32 v13, 1, v0
  v_lshlrev_b32 v13, 8, v13
  v_lshl_add_u32 v13, v2, 4, v13
  s_lshl_b32 s6, s80, 15
  s_lshl_b32 s7, s15, 13
  s_add_u32 s6, s6, s7
  s_lshl_b32 s7, s77, 7
  s_add_u32 s6, s6, s7
  s_add_u32 s6, s6, 262144
  s_add_u32 s7, s6, 4096
  v_and_b32 v14, 15, v0
  v_lshlrev_b32 v14, 6, v14
  v_lshl_add_u32 v14, v2, 4, v14
  s_waitcnt lgkmcnt(0)
  s_barrier
  ds_read_b128 v[72:75], v13 offset:8704
  ds_read_b128 v[76:79], v13 offset:8768
  ds_read_b128 v[80:83], v13 offset:8832
  ds_read_b128 v[84:87], v13 offset:8896
  s_waitcnt lgkmcnt(3)
  v_mfma_f32_16x16x32_bf16 v[88:91], v[32:35], v[72:75], 0
  v_mfma_f32_16x16x32_bf16 v[92:95], v[48:51], v[72:75], 0
  s_waitcnt lgkmcnt(2)
  v_mfma_f32_16x16x32_bf16 v[88:91], v[36:39], v[76:79], v[88:91]
  v_mfma_f32_16x16x32_bf16 v[92:95], v[52:55], v[76:79], v[92:95]
  s_waitcnt lgkmcnt(1)
  v_mfma_f32_16x16x32_bf16 v[88:91], v[40:43], v[80:83], v[88:91]
  v_mfma_f32_16x16x32_bf16 v[92:95], v[56:59], v[80:83], v[92:95]
  s_waitcnt lgkmcnt(0)
  v_mfma_f32_16x16x32_bf16 v[88:91], v[44:47], v[84:87], v[88:91]
  v_mfma_f32_16x16x32_bf16 v[92:95], v[60:63], v[84:87], v[92:95]
  s_nop 4
  s_mov_b32 exec_lo, 0x30003
  s_mov_b32 exec_hi, 0x30003
  buffer_store_dwordx4 v[88:91], v14, s[52:55], s6 offen sc1
  buffer_store_dwordx4 v[92:95], v14, s[52:55], s7 offen sc1
  s_endpgm
L_t2:
  s_cmp_eq_u32 s76, 6
  s_cbranch_scc0 L_t3
  s_cmp_eq_u32 s89, 1
  s_cbranch_scc1 L_stats
  s_cmp_eq_u32 s82, 3
  s_cbranch_scc0 L_end
  s_cmp_ge_u32 s83, 40
  s_cselect_b32 s12, 1, 0
  s_mul_i32 s7, s12, 40
  s_sub_u32 s13, s83, s7
  v_bfe_u32 v10, v0, 2, 1
  v_mul_u32_u24 v10, 1280, v10
  v_and_b32 v11, 3, v0
  v_lshl_add_u32 v10, v11, 3, v10
  v_lshrrev_b32 v11, 5, v0
  v_lshl_add_u32 v10, v11, 2, v10
  s_lshl_b32 s8, s13, 5
  buffer_load_dword v4, v10, s[56:59], s8 offen
  s_lshl_b32 s9, s13, 12
  s_add_u32 s9, s9, 262144
  s_barrier
  s_barrier
L_epoll:
  buffer_load_dwordx4 v[64:67], v1, s[52:55], s9 offen offset:0 sc1
  buffer_load_dwordx4 v[68:71], v1, s[52:55], s9 offen offset:1024 sc1
  buffer_load_dwordx4 v[72:75], v1, s[52:55], s9 offen offset:2048 sc1
  buffer_load_dwordx4 v[76:79], v1, s[52:55], s9 offen offset:3072 sc1
  s_waitcnt vmcnt(3)
  v_max3_u32 v22, v64, v65, v66
  v_max_u32 v22, v22, v67
  s_waitcnt vmcnt(2)
  v_max3_u32 v23, v68, v69, v70
  v_max_u32 v23, v23, v71
  s_waitcnt vmcnt(1)
  v_max3_u32 v22, v22, v72, v73
  v_max3_u32 v22, v22, v74, v75
  s_waitcnt vmcnt(0)
  v_max3_u32 v23, v23, v76, v77
  v_max3_u32 v23, v23, v78, v79
  v_max_u32 v22, v22, v23
  v_cmp_eq_u32 vcc, -1, v22
  s_cbranch_vccz L_ego
  s_mov_b64 exec, vcc
  s_add_u32 s88, s88, 1
  s_cmp_gt_u32 s88, 0x40000
  s_cbranch_scc1 L_ego
  s_bcnt1_i32_b64 s4, vcc
  s_cmp_le_u32 s4, 40
  s_cbranch_scc1 L_epoll
  s_sleep 16
  s_branch L_epoll
L_ego:
  s_mov_b64 exec, -1
  v_add_f32 v64, v64, v68
  v_add_f32 v72, v72, v76
  v_add_f32 v65, v65, v69
  v_add_f32 v73, v73, v77
  v_add_f32 v66, v66, v70
  v_add_f32 v74, v74, v78
  v_add_f32 v67, v67, v71
  v_add_f32 v75, v75, v79
  v_add_f32 v64, v64, v72
  v_add_f32 v65, v65, v73
  v_add_f32 v66, v66, v74
  v_add_f32 v67, v67, v75
  s_nop 0
  v_add_f32_dpp v64, v64, v64 row_ror:8 row_mask:0xf bank_mask:0xf
  v_add_f32_dpp v65, v65, v65 row_ror:8 row_mask:0xf bank_mask:0xf
  v_add_f32_dpp v66, v66, v66 row_ror:8 row_mask:0xf bank_mask:0xf
  v_add_f32_dpp v67, v67, v67 row_ror:8 row_mask:0xf bank_mask:0xf
  s_nop 1
  v_permlane32_swap_b32 v64, v66
  v_permlane32_swap_b32 v65, v67
  v_add_f32 v64, v64, v66
  v_add_f32 v65, v65, v67
  v_mov_b32 v66, v64
  v_mov_b32 v67, v65
  s_nop 1
  v_permlane16_swap_b32 v64, v66
  v_permlane16_swap_b32 v65, v67
  v_add_f32 v64, v64, v66
  v_add_f32 v65, v65, v67
  v_cvt_pk_bf16_f32 v66, v64, v65
  v_lshlrev_b32 v64, 16, v66
  v_and_b32 v65, 0xffff0000, v66
  v_lshlrev_b32 v5, 16, v4
  v_and_b32 v6, 0xffff0000, v4
  v_add_f32 v64, v64, v5
  v_add_f32 v65, v65, v6
  v_cvt_pk_bf16_f32 v66, v64, v65
  v_and_b32 v3, 35, v0
  s_lshl_b32 s6, s12, 2
  v_add_u32 v3, s6, v3
  v_lshlrev_b32 v3, 2, v3
  ds_bpermute_b32 v4, v3, v66
  s_mul_i32 s8, s12, 1280
  s_lshl_b32 s7, s13, 5
  s_add_u32 s8, s8, s7
  v_and_b32 v3, 3, v0
  v_lshlrev_b32 v2, 3, v3
  v_lshrrev_b32 v3, 5, v0
  v_lshl_add_u32 v2, v3, 2, v2
  s_mul_i32 s9, s83, 6912
  s_add_u32 s9, s9, 1048576
  s_add_u32 s10, s9, 4096
  s_mov_b32 s60, s38
  s_mov_b32 s61, s39
  s_add_u32 s62, s9, 6912
  s_mov_b32 s63, 0x20000
  s_waitcnt lgkmcnt(0)
  s_barrier
  s_barrier
L_fpoll:
  buffer_load_dwordx4 v[32:35], v1, s[60:63], s9 offen offset:0 sc1
  buffer_load_dwordx4 v[36:39], v1, s[60:63], s9 offen offset:1024 sc1
  buffer_load_dwordx4 v[40:43], v1, s[60:63], s9 offen offset:2048 sc1
  buffer_load_dwordx4 v[44:47], v1, s[60:63], s9 offen offset:3072 sc1
  buffer_load_dwordx4 v[48:51], v1, s[60:63], s10 offen offset:0 sc1
  buffer_load_dwordx4 v[52:55], v1, s[60:63], s10 offen offset:1024 sc1
  buffer_load_dwordx4 v[56:59], v1, s[60:63], s10 offen offset:2048 sc1
  s_waitcnt vmcnt(6)
  v_max3_u32 v22, v32, v33, v34
  v_max_u32 v22, v22, v35
  s_waitcnt vmcnt(5)
  v_max3_u32 v23, v36, v37, v38
  v_max_u32 v23, v23, v39
  s_waitcnt vmcnt(4)
  v_max3_u32 v22, v22, v40, v41
  v_max3_u32 v22, v22, v42, v43
  s_waitcnt vmcnt(3)
  v_max3_u32 v23, v23, v44, v45
  v_max3_u32 v23, v23, v46, v47
  s_waitcnt vmcnt(2)
  v_max3_u32 v22, v22, v48, v49
  v_max3_u32 v22, v22, v50, v51
  s_waitcnt vmcnt(1)
  v_max3_u32 v23, v23, v52, v53
  v_max3_u32 v23, v23, v54, v55
  s_waitcnt vmcnt(0)
  v_max3_u32 v22, v22, v56, v57
  v_max3_u32 v22, v22, v58, v59
  v_max_u32 v22, v22, v23
  v_cmp_eq_u32 vcc, -1, v22
  s_cbranch_vccz L_fgo
  s_mov_b64 exec, vcc
  s_add_u32 s88, s88, 1
  s_cmp_gt_u32 s88, 0x40000
  s_cbranch_scc1 L_fgo
  s_branch L_fpoll
L_fgo:
  s_mov_b64 exec, -1
  v_add_f32 v32, v32, v36
  v_add_f32 v40, v40, v44
  v_add_f32 v48, v48, v52
  v_add_f32 v33, v33, v37
  v_add_f32 v41, v41, v45
  v_add_f32 v49, v49, v53
  v_add_f32 v34, v34, v38
  v_add_f32 v42, v42, v46
  v_add_f32 v50, v50, v54
  v_add_f32 v35, v35, v39
  v_add_f32 v43, v43, v47
  v_add_f32 v51, v51, v55
  v_add_f32 v32, v32, v40
  v_add_f32 v48, v48, v56
  v_add_f32 v33, v33, v41
  v_add_f32 v49, v49, v57
  v_add_f32 v34, v34, v42
  v_add_f32 v50, v50, v58
  v_add_f32 v35, v35, v43
  v_add_f32 v51, v51, v59
  v_add_f32 v32, v32, v48
  v_add_f32 v33, v33, v49
  v_add_f32 v34, v34, v50
  v_add_f32 v35, v35, v51
  s_nop 0
  v_add_f32_dpp v32, v32, v32 row_ror:4 row_mask:0xf bank_mask:0xf
  v_add_f32_dpp v33, v33, v33 row_ror:4 row_mask:0xf bank_mask:0xf
  v_add_f32_dpp v34, v34, v34 row_ror:4 row_mask:0xf bank_mask:0xf
  v_add_f32_dpp v35, v35, v35 row_ror:4 row_mask:0xf bank_mask:0xf
  v_add_f32_dpp v32, v32, v32 row_ror:8 row_mask:0xf bank_mask:0xf
  v_add_f32_dpp v33, v33, v33 row_ror:8 row_mask:0xf bank_mask:0xf
  v_add_f32_dpp v34, v34, v34 row_ror:8 row_mask:0xf bank_mask:0xf
  v_add_f32_dpp v35, v35, v35 row_ror:8 row_mask:0xf bank_mask:0xf
  s_nop 1
  v_permlane32_swap_b32 v32, v34
  v_permlane32_swap_b32 v33, v35
  v_add_f32 v32, v32, v34
  v_add_f32 v33, v33, v35
  v_mov_b32 v34, v32
  v_mov_b32 v35, v33
  s_nop 1
  v_permlane16_swap_b32 v32, v34
  v_permlane16_swap_b32 v33, v35
  v_add_f32 v32, v32, v34
  v_add_f32 v33, v33, v35
  v_cvt_pk_bf16_f32 v34, v32, v33
  v_lshlrev_b32 v32, 16, v34
  v_and_b32 v33, 0xffff0000, v34
  v_lshlrev_b32 v5, 16, v4
  v_and_b32 v6, 0xffff0000, v4
  v_add_f32 v32, v32, v5
  v_add_f32 v33, v33, v6
  v_cvt_pk_bf16_f32 v34, v32, v33
  s_mov_b32 exec_lo, 0xf
  s_mov_b32 exec_hi, 0xf
  buffer_store_dword v34, v2, s[72:75], s8 offen
  s_endpgm
L_t3:
  s_cmp_lt_u32 s76, 8
  s_cbranch_scc1 L_end
  s_sub_u32 s15, s76, 8
  v_lshrrev_b32 v2, 4, v0
  v_bfe_u32 v3, v0, 2, 2
  v_and_b32 v7, 3, v0
  s_cmp_eq_u32 s89, 1
  s_cbranch_scc0 L_t4
  s_and_b32 s13, s15, 1
  s_lshr_b32 s14, s15, 1
  v_lshl_add_u32 v5, v2, 3, v3
  v_lshlrev_b32 v5, 7, v5
  v_lshl_add_u32 v5, v7, 3, v5
  s_lshl_b32 s6, s13, 14
  s_lshl_b32 s7, s14, 5
  s_add_u32 s6, s6, s7
  v_add_u32 v5, s6, v5
  ds_read_b64_tr_b16 v[32:33], v5 offset:49152
  ds_read_b64_tr_b16 v[34:35], v5 offset:49664
  ds_read_b64_tr_b16 v[36:37], v5 offset:53248
  ds_read_b64_tr_b16 v[38:39], v5 offset:53760
  ds_read_b64_tr_b16 v[40:41], v5 offset:57344
  ds_read_b64_tr_b16 v[42:43], v5 offset:57856
  ds_read_b64_tr_b16 v[44:45], v5 offset:61440
  ds_read_b64_tr_b16 v[46:47], v5 offset:61952
  v_mov_b32 v12, 0x3f803f80
  v_lshlrev_b32 v13, 2, v0
  ds_write_b32 v13, v12 offset:11776
  v_and_b32 v12, 15, v0
  v_min_u32 v12, 2, v12
  v_lshlrev_b32 v12, 8, v12
  v_lshl_add_u32 v15, v2, 4, v12
  s_lshl_b32 s8, s90, 2
  s_add_u32 s12, s14, s8
  s_mul_i32 s12, s12, 2560
  s_lshl_b32 s7, s97, 9
  s_add_u32 s12, s12, s7
  s_mul_i32 s8, s13, 192
  s_add_u32 s12, s12, s8
  s_add_u32 s12, s12, 3145728
  v_and_b32 v14, 15, v0
  v_lshlrev_b32 v14, 6, v14
  v_lshl_add_u32 v14, v2, 4, v14
  s_lshl_b32 s10, s97, 3
  s_add_u32 s10, s10, s15
  v_bfe_u32 v10, v0, 2, 1
  v_mul_u32_u24 v10, 1280, v10
  v_and_b32 v11, 3, v0
  v_lshl_add_u32 v10, v11, 3, v10
  v_lshrrev_b32 v11, 5, v0
  v_lshl_add_u32 v10, v11, 2, v10
  s_lshl_b32 s8, s10, 5
  buffer_load_dword v4, v10, s[56:59], s8 offen
  s_lshl_b32 s9, s10, 12
  s_add_u32 s9, s9, 262144
  v_bfe_u32 v16, v0, 2, 1
  v_lshlrev_b32 v16, 8, v16
  v_lshl_add_u32 v16, v7, 3, v16
  v_lshl_add_u32 v16, v11, 2, v16
  s_lshl_b32 s6, s15, 5
  v_add_u32 v16, s6, v16
  s_barrier
  s_barrier
L_npoll:
  buffer_load_dwordx4 v[64:67], v1, s[52:55], s9 offen offset:0 sc1
  buffer_load_dwordx4 v[68:71], v1, s[52:55], s9 offen offset:1024 sc1
  buffer_load_dwordx4 v[72:75], v1, s[52:55], s9 offen offset:2048 sc1
  buffer_load_dwordx4 v[76:79], v1, s[52:55], s9 offen offset:3072 sc1
  s_waitcnt vmcnt(3)
  v_max3_u32 v22, v64, v65, v66
  v_max_u32 v22, v22, v67
  s_waitcnt vmcnt(2)
  v_max3_u32 v23, v68, v69, v70
  v_max_u32 v23, v23, v71
  s_waitcnt vmcnt(1)
  v_max3_u32 v22, v22, v72, v73
  v_max3_u32 v22, v22, v74, v75
  s_waitcnt vmcnt(0)
  v_max3_u32 v23, v23, v76, v77
  v_max3_u32 v23, v23, v78, v79
  v_max_u32 v22, v22, v23
  v_cmp_eq_u32 vcc, -1, v22
  s_cbranch_vccz L_ngo
  s_mov_b64 exec, vcc
  s_add_u32 s88, s88, 1
  s_cmp_gt_u32 s88, 0x40000
  s_cbranch_scc1 L_ngo
  s_bcnt1_i32_b64 s4, vcc
  s_cmp_le_u32 s4, 40
  s_cbranch_scc1 L_npoll
  s_sleep 16
  s_branch L_npoll
L_ngo:
  s_mov_b64 exec, -1
  v_add_f32 v64, v64, v68
  v_add_f32 v72, v72, v76
  v_add_f32 v65, v65, v69
  v_add_f32 v73, v73, v77
  v_add_f32 v66, v66, v70
  v_add_f32 v74, v74, v78
  v_add_f32 v67, v67, v71
  v_add_f32 v75, v75, v79
  v_add_f32 v64, v64, v72
  v_add_f32 v65, v65, v73
  v_add_f32 v66, v66, v74
  v_add_f32 v67, v67, v75
  s_nop 0
  v_add_f32_dpp v64, v64, v64 row_ror:8 row_mask:0xf bank_mask:0xf
  v_add_f32_dpp v65, v65, v65 row_ror:8 row_mask:0xf bank_mask:0xf
  v_add_f32_dpp v66, v66, v66 row_ror:8 row_mask:0xf bank_mask:0xf
  v_add_f32_dpp v67, v67, v67 row_ror:8 row_mask:0xf bank_mask:0xf
  s_nop 1
  v_permlane32_swap_b32 v64, v66
  v_permlane32_swap_b32 v65, v67
  v_add_f32 v64, v64, v66
  v_add_f32 v65, v65, v67
  v_mov_b32 v66, v64
  v_mov_b32 v67, v65
  s_nop 1
  v_permlane16_swap_b32 v64, v66
  v_permlane16_swap_b32 v65, v67
  v_add_f32 v64, v64, v66
  v_add_f32 v65, v65, v67
  v_cvt_pk_bf16_f32 v66, v64, v65
  v_lshlrev_b32 v64, 16, v66
  v_and_b32 v65, 0xffff0000, v66
  v_lshlrev_b32 v5, 16, v4
  v_and_b32 v6, 0xffff0000, v4
  v_add_f32 v64, v64, v5
  v_add_f32 v65, v65, v6
  v_cvt_pk_bf16_f32 v66, v64, v65
  ds_write_b32 v16, v66 offset:11264
  s_waitcnt lgkmcnt(0)
  s_barrier
  ds_read_b128 v[64:67], v15 offset:11264
  ds_read_b128 v[68:71], v15 offset:11328
  ds_read_b128 v[72:75], v15 offset:11392
  ds_read_b128 v[76:79], v15 offset:11456
  s_waitcnt lgkmcnt(3)
  v_mfma_f32_16x16x32_bf16 v[88:91], v[32:35], v[64:67], 0
  s_waitcnt lgkmcnt(2)
  v_mfma_f32_16x16x32_bf16 v[88:91], v[36:39], v[68:71], v[88:91]
  s_waitcnt lgkmcnt(1)
  v_mfma_f32_16x16x32_bf16 v[88:91], v[40:43], v[72:75], v[88:91]
  s_waitcnt lgkmcnt(0)
  v_mfma_f32_16x16x32_bf16 v[88:91], v[44:47], v[76:79], v[88:91]
  s_nop 5
  s_mov_b32 exec_lo, 0x70007
  s_mov_b32 exec_hi, 0x70007
  buffer_store_dwordx4 v[88:91], v14, s[52:55], s12 offen sc1
  s_endpgm
L_stats:
  s_mul_i32 s11, s90, 10240
  s_lshl_b32 s7, s97, 9
  s_add_u32 s11, s11, s7
  s_add_u32 s11, s11, 3146112
  v_and_b32 v7, 3, v0
  v_lshrrev_b32 v11, 5, v0
  v_mul_u32_u24 v16, 2560, v7
  v_lshl_add_u32 v16, v11, 4, v16
  v_lshlrev_b32 v17, 3, v0
  v_mov_b32 v106, 0
  v_mov_b32 v107, 0
  s_barrier
  s_barrier
  s_barrier
  ds_read_b64 v[96:97], v17 offset:11264
  s_waitcnt lgkmcnt(0)
  v_lshlrev_b32 v100, 16, v96
  v_and_b32 v101, 0xffff0000, v96
  v_lshlrev_b32 v102, 16, v97
  v_and_b32 v103, 0xffff0000, v97
  v_add_f32 v104, v100, v101
  v_add_f32 v105, v102, v103
  v_add_f32 v104, v104, v105
  s_nop 1
  v_add_f32_dpp v104, v104, v104 quad_perm:[1,0,3,2] row_mask:0xf bank_mask:0xf
  s_nop 1
  v_add_f32_dpp v104, v104, v104 quad_perm:[2,3,0,1] row_mask:0xf bank_mask:0xf
  s_nop 1
  v_add_f32_dpp v104, v104, v104 row_half_mirror row_mask:0xf bank_mask:0xf
  s_nop 1
  v_add_f32_dpp v104, v104, v104 row_mirror row_mask:0xf bank_mask:0xf
  v_mov_b32 v105, v104
  s_nop 1
  v_permlane16_swap_b32 v104, v105
  v_add_f32 v104, v104, v105
  v_mul_f32 v104, 0x3c000000, v104
  v_sub_f32 v100, v100, v104
  v_sub_f32 v101, v101, v104
  v_sub_f32 v102, v102, v104
  v_sub_f32 v103, v103, v104
  v_mul_f32 v105, v100, v100
  v_mul_f32 v98, v102, v102
  v_fmac_f32 v105, v101, v101
  v_fmac_f32 v98, v103, v103
  v_add_f32 v105, v105, v98
  s_nop 1
  v_add_f32_dpp v105, v105, v105 quad_perm:[1,0,3,2] row_mask:0xf bank_mask:0xf
  s_nop 1
  v_add_f32_dpp v105, v105, v105 quad_perm:[2,3,0,1] row_mask:0xf bank_mask:0xf
  s_nop 1
  v_add_f32_dpp v105, v105, v105 row_half_mirror row_mask:0xf bank_mask:0xf
  s_nop 1
  v_add_f32_dpp v105, v105, v105 row_mirror row_mask:0xf bank_mask:0xf
  v_mov_b32 v98, v105
  s_nop 1
  v_permlane16_swap_b32 v105, v98
  v_add_f32 v105, v105, v98
  s_mov_b32 exec_lo, 0xf
  s_mov_b32 exec_hi, 0xf
  buffer_store_dwordx4 v[104:107], v16, s[52:55], s11 offen sc1
  s_endpgm
L_t4:
  s_cmp_eq_u32 s89, 2
  s_cbranch_scc0 L_end
  v_lshl_add_u32 v6, v2, 2, v3
  v_mul_u32_u24 v6, 1280, v6
  v_lshl_add_u32 v6, v7, 3, v6
  s_mul_i32 s6, s15, 160
  v_add_u32 v6, s6, v6
  ds_read_b64_tr_b16 v[52:53], v6 offset:49152
  ds_read_b64_tr_b16 v[54:55], v6 offset:49184
  ds_read_b64_tr_b16 v[56:57], v6 offset:49216
  ds_read_b64_tr_b16 v[58:59], v6 offset:49248
  ds_read_b64_tr_b16 v[60:61], v6 offset:49280
  s_mul_i32 s9, s90, 2560
  s_add_u32 s9, s9, 3145728
  s_mul_i32 s6, s15, 34560
  s_lshl_b32 s7, s90, 6
  s_add_u32 s12, s6, s7
  s_add_u32 s12, s12, 1048576
  v_and_b32 v14, 1, v0
  v_mul_u32_u24 v14, 276480, v14
  v_lshl_add_u32 v14, v2, 4, v14
  v_min_u32 v9, 25, v0
  v_lshlrev_b32 v9, 4, v9
  v_and_b32 v16, 1, v0
  v_lshlrev_b32 v17, 6, v16
  v_lshl_add_u32 v17, v2, 4, v17
  v_lshlrev_b32 v19, 4, v2
  v_lshlrev_b32 v20, 4, v16
  v_mov_b32 v90, 0x43000000
  s_barrier
  s_barrier
  s_cmp_eq_u32 s15, 0
  s_cbranch_scc0 L_gb
L_gpoll:
  buffer_load_dwordx4 v[64:67], v9, s[52:55], s9 offen offset:0 sc1
  buffer_load_dwordx4 v[68:71], v9, s[52:55], s9 offen offset:512 sc1
  buffer_load_dwordx4 v[72:75], v9, s[52:55], s9 offen offset:1024 sc1
  buffer_load_dwordx4 v[76:79], v9, s[52:55], s9 offen offset:1536 sc1
  buffer_load_dwordx4 v[80:83], v9, s[52:55], s9 offen offset:2048 sc1
  s_waitcnt vmcnt(4)
  v_max3_u32 v22, v64, v65, v66
  v_max_u32 v22, v22, v67
  s_waitcnt vmcnt(3)
  v_max3_u32 v23, v68, v69, v70
  v_max_u32 v23, v23, v71
  s_waitcnt vmcnt(2)
  v_max3_u32 v22, v22, v72, v73
  v_max3_u32 v22, v22, v74, v75
  s_waitcnt vmcnt(1)
  v_max3_u32 v23, v23, v76, v77
  v_max3_u32 v23, v23, v78, v79
  s_waitcnt vmcnt(0)
  v_max3_u32 v22, v22, v80, v81
  v_max3_u32 v22, v22, v82, v83
  v_max_u32 v22, v22, v23
  v_cmp_eq_u32 vcc, -1, v22
  s_cbranch_vccz L_ggo
  s_mov_b64 exec, vcc
  s_add_u32 s88, s88, 1
  s_cmp_gt_u32 s88, 0x40000
  s_cbranch_scc1 L_ggo
  s_branch L_gpoll
L_ggo:
  s_mov_b64 exec, -1
  v_add_f32 v84, v64, v68
  v_add_f32 v96, v72, v76
  v_add_f32 v85, v65, v69
  v_add_f32 v97, v73, v77
  v_add_f32 v86, v66, v70
  v_add_f32 v98, v74, v78
  v_add_f32 v87, v67, v71
  v_add_f32 v99, v75, v79
  v_add_f32 v84, v84, v80
  v_add_f32 v85, v85, v81
  v_add_f32 v86, v86, v82
  v_add_f32 v87, v87, v83
  v_add_f32 v84, v84, v96
  v_add_f32 v85, v85, v97
  v_add_f32 v86, v86, v98
  v_add_f32 v87, v87, v99
  ds_write_b128 v9, v[84:87] offset:13824
  v_mul_f32 v92, 0x3e4ccccd, v84
  v_sub_f32 v96, v64, v92
  v_sub_f32 v97, v68, v92
  v_sub_f32 v98, v72, v92
  v_sub_f32 v99, v76, v92
  v_sub_f32 v100, v80, v92
  v_mul_f32 v88, v96, v96
  v_mul_f32 v89, v97, v97
  v_fmac_f32 v88, v98, v98
  v_fmac_f32 v89, v99, v99
  v_fmac_f32 v88, v100, v100
  v_add_f32 v88, v88, v89
  v_fma_f32 v93, v88, v90, v85
  v_mul_f32 v93, 0x3acccccd, v93
  v_cvt_pk_bf16_f32 v94, v92, v93
  v_lshlrev_b32 v92, 16, v94
  v_and_b32 v93, 0xffff0000, v94
  v_add_f32 v93, 0x3727c5ac, v93
  v_cvt_pk_bf16_f32 v93, v93, v93
  v_and_b32 v93, 0xffff0000, v93
  v_sqrt_f32 v93, v93
  s_nop 0
  v_cvt_pk_bf16_f32 v93, v93, v93
  v_and_b32 v93, 0xffff0000, v93
  v_rcp_f32 v93, v93
  s_mov_b32 exec_lo, 0x3000000
  s_mov_b32 exec_hi, 0
  ds_write_b64 v9, v[92:93] offset:13952
  s_mov_b64 exec, -1
L_gb:
  s_waitcnt lgkmcnt(0)
  s_barrier
  ds_read_b128 v[64:67], v17 offset:13824
  ds_read_b128 v[68:71], v19 offset:13952
  ds_read_b128 v[72:75], v17 offset:14016
  ds_read_b128 v[76:79], v19 offset:14144
  ds_read_b64 v[80:81], v20 offset:14336
  s_waitcnt lgkmcnt(0)
  v_fma_f32 v64, -v80, v68, v64
  v_fma_f32 v72, -v80, v76, v72
  v_fma_f32 v65, -v80, v69, v65
  v_fma_f32 v73, -v80, v77, v73
  v_fma_f32 v66, -v80, v70, v66
  v_fma_f32 v74, -v80, v78, v74
  v_fma_f32 v67, -v80, v71, v67
  v_fma_f32 v75, -v80, v79, v75
  v_mul_f32 v64, v64, v81
  v_mul_f32 v72, v72, v81
  v_mul_f32 v65, v65, v81
  v_mul_f32 v73, v73, v81
  v_mul_f32 v66, v66, v81
  v_mul_f32 v74, v74, v81
  v_mul_f32 v67, v67, v81
  v_mul_f32 v75, v75, v81
  v_cvt_pk_bf16_f32 v84, v64, v65
  v_cvt_pk_bf16_f32 v85, v66, v67
  v_cvt_pk_bf16_f32 v86, v72, v73
  v_cvt_pk_bf16_f32 v87, v74, v75
  v_lshlrev_b32 v64, 16, v84
  v_and_b32 v65, 0xffff0000, v84
  v_lshlrev_b32 v66, 16, v85
  v_and_b32 v67, 0xffff0000, v85
  v_lshlrev_b32 v72, 16, v86
  v_and_b32 v73, 0xffff0000, v86
  v_lshlrev_b32 v74, 16, v87
  v_and_b32 v75, 0xffff0000, v87
  v_mul_f32 v64, v64, v72
  v_mul_f32 v65, v65, v73
  v_mul_f32 v66, v66, v74
  v_mul_f32 v67, v67, v75
  v_cvt_pk_bf16_f32 v10, v64, v65
  v_cvt_pk_bf16_f32 v11, v66, v67
  s_nop 1
  v_mfma_f32_16x16x16_bf16 v[104:107], v[52:53], v[10:11], 0
  v_mfma_f32_16x16x16_bf16 v[108:111], v[54:55], v[10:11], 0
  v_mfma_f32_16x16x16_bf16 v[112:115], v[56:57], v[10:11], 0
  v_mfma_f32_16x16x16_bf16 v[116:119], v[58:59], v[10:11], 0
  v_mfma_f32_16x16x16_bf16 v[120:123], v[60:61], v[10:11], 0
  s_nop 1
  s_mov_b32 exec_lo, 0x30003
  s_mov_b32 exec_hi, 0x30003
  buffer_store_dwordx4 v[104:107], v14, s[52:55], s12 offen sc1
  s_add_u32 s12, s12, 6912
  buffer_store_dwordx4 v[108:111], v14, s[52:55], s12 offen sc1
  s_add_u32 s12, s12, 6912
  buffer_store_dwordx4 v[112:115], v14, s[52:55], s12 offen sc1
  s_add_u32 s12, s12, 6912
  buffer_store_dwordx4 v[116:119], v14, s[52:55], s12 offen sc1
  s_add_u32 s12, s12, 6912
  buffer_store_dwordx4 v[120:123], v14, s[52:55], s12 offen sc1
L_end:
  s_endpgm
.section .rodata,"a"
.p2align 6
.amdhsa_kernel sequential_preLN__mha_block_cached__glu_gated_bilinear__decode_kernel
  .amdhsa_next_free_vgpr 128
  .amdhsa_next_free_sgpr 102
  .amdhsa_accum_offset 128
  .amdhsa_group_segment_fixed_size 0
  .amdhsa_kernarg_size 96
  .amdhsa_user_sgpr_count 2
  .amdhsa_user_sgpr_kernarg_segment_ptr 1
  .amdhsa_system_sgpr_workgroup_id_x 1
  .amdhsa_float_denorm_mode_32 3
.end_amdhsa_kernel
```
